```python
import torch

def _softmax(x, axis=-1):
    return torch.softmax(x, dim=axis)
def _gelu(x):
    return torch.nn.functional.gelu(x, approximate="tanh")
def _silu(x):
    return torch.nn.functional.silu(x)
def _sigmoid(x):
    return torch.sigmoid(x)
def _layernorm(x, axis=-1, eps=1e-5):
    m = x.mean(dim=axis, keepdim=True)
    v = x.var(dim=axis, keepdim=True, unbiased=False)
    return (x - m) / torch.sqrt(v + eps)
def _scatter_add(tgt, idx, src, axis=0):
    return tgt.clone().index_add_(axis, idx, src)
def _segment_sum(src, seg, n):
    out = torch.zeros((n,) + src.shape[1:], dtype=src.dtype)
    return out.index_add_(0, seg, src)
def _pad(x, pw):
    flat = tuple(v for pair in reversed(pw) for v in pair)
    return torch.nn.functional.pad(x, flat)

kernel_name = 'standalone__paged_block_table_kv_radixattention__decode'

def setup_inputs():

    _w = (lambda a: (lambda t: t.to(torch.bfloat16) if t.is_floating_point() else t)(torch.as_tensor(a)))
    B, H, Hkv, Dh = 4, 32, 32, 128
    Lk = 8192
    bs = 16
    nb = max(2, Lk // bs)
    P = max(1, nb // 2)
    n_phys = P + B * (nb - P)
    shared = torch.arange(P, dtype=torch.int64)
    priv = P + torch.arange(B * (nb - P), dtype=torch.int64).reshape(B, nb - P)
    bt = torch.cat([torch.tile(shared[None, :], (B, 1)), priv], dim=1)
    ctx = nb * bs - (torch.arange(1, B + 1, dtype=torch.int64) * 2654435761) % max(1, (nb * bs - P * bs) // 2)
    return {
        "q": _w((lambda *s: torch.randn(*s, dtype=torch.bfloat16) * 0.8)(B, H, Dh)),
        "k_cache": _w((lambda *s: torch.randn(*s, dtype=torch.bfloat16) * 0.8)(n_phys, bs, Hkv, Dh)),
        "v_cache": _w((lambda *s: torch.randn(*s, dtype=torch.bfloat16) * 0.05)(n_phys, bs, Hkv, Dh)),
        "block_table": _w(bt.to(torch.int64)),
        "ctx_lens": _w(torch.as_tensor(ctx).to(torch.int64)),
    }

def reference(q, k_cache, v_cache, block_table, ctx_lens):
    B, H, Dh = q.shape
    n_phys, bs, Hkv, _ = k_cache.shape
    nb = block_table.shape[1]
    Lk = nb * bs
    rep = H // Hkv
    k = k_cache[block_table].reshape(B, Lk, Hkv, Dh)
    v = v_cache[block_table].reshape(B, Lk, Hkv, Dh)
    k = (lambda x, n, axis: torch.repeat_interleave(x, n, dim=axis))(k, rep, axis=2)
    v = (lambda x, n, axis: torch.repeat_interleave(x, n, dim=axis))(v, rep, axis=2)
    scores = torch.einsum("bhd,bkhd->bhk", q, k) * (Dh ** -0.5)
    pos = torch.arange(Lk)
    valid = pos[None, :] < ctx_lens[:, None]
    scores = torch.where(valid[:, None, :], scores, -1e9)
    p = _softmax(scores, axis=-1)
    return torch.einsum("bhk,bkhd->bhd", p, v)
```

```asm
; @launch grid=(256,1,1) block=(320,1,1) lds=86016
.amdgcn_target "amdgcn-amd-amdhsa--gfx950"
.text
.globl standalone__paged_block_table_kv_radixattention__decode_kernel
.p2align 8
.type standalone__paged_block_table_kv_radixattention__decode_kernel,@function
standalone__paged_block_table_kv_radixattention__decode_kernel:
    s_cmp_ge_u32 s2, 256
    s_cbranch_scc1 L_exit2
    s_load_dwordx16 s[8:23], s[0:1], 0
    v_mov_b32 v216, 0
    ds_write_b32 v216, v216 offset:0
    v_and_b32 v1, 63, v0
    v_lshrrev_b32 v10, 6, v0
    s_nop 0
    v_readfirstlane_b32 s36, v10
    s_lshr_b32 s3, s2, 6
    s_lshl_b32 s3, s3, 3
    s_and_b32 s4, s2, 7
    s_or_b32 s38, s3, s4
    s_bfe_u32 s37, s2, 0x30003
    s_mov_b32 s39, 0x3e0293ee
    s_mov_b32 s40, 0xffff0000
    v_lshlrev_b32 v69, 4, v1
    s_lshl_b32 s3, s37, 10
    v_add_u32 v71, s3, v69
    s_lshl_b32 s4, s36, 2
    s_lshl_b32 s5, s4, 13
    v_add_u32 v2, s5, v71
    v_add_u32 v3, 8192, v2
    v_add_u32 v4, 16384, v2
    v_add_u32 v5, 24576, v2
    v_bfe_u32 v70, v1, 2, 1
    v_bfe_u32 v6, v1, 3, 1
    v_lshlrev_b32 v6, 1, v6
    v_or3_b32 v6, v6, v70, s4
    v_mov_b32 v7, 0xff800000
    v_mov_b32 v9, 1
    v_add_u32 v74, 8192, v71
    v_add_u32 v75, 16384, v71
    v_add_u32 v76, 24576, v71
    s_lshl_b32 s3, s37, 3
    s_add_u32 s3, s3, s36
    s_lshl_b32 s3, s3, 8
    s_add_u32 s3, s3, 0x400000
    v_mov_b32 v8, s3
    s_lshl_b32 s3, s37, 2
    s_add_u32 s3, s3, 128
    v_mov_b32 v214, s3
    v_bfe_u32 v78, v1, 2, 3
    v_and_b32 v79, 3, v1
    v_lshlrev_b32 v77, 7, v78
    v_lshl_add_u32 v77, v79, 11, v77
    s_lshl_b32 s5, s38, 2
    v_add_u32 v77, s5, v77
    s_waitcnt lgkmcnt(0)
    s_barrier
    s_cmp_eq_u32 s36, 4
    s_cbranch_scc1 L_builder
    s_add_u32 s6, s14, s5
    s_addc_u32 s7, s15, 0
    s_load_dword s60, s[6:7], 0x0
    s_load_dword s61, s[6:7], 0x80
    s_load_dwordx4 s[32:35], s[16:17], 0
    s_mov_b32 s24, s10
    s_and_b32 s25, s11, 0xffff
    s_mov_b32 s26, 0xa000000
    s_mov_b32 s27, 0x00020000
    s_mov_b32 s28, s12
    s_and_b32 s29, s13, 0xffff
    s_mov_b32 s30, 0xa000000
    s_mov_b32 s31, 0x00020000
    s_waitcnt lgkmcnt(0)
    s_add_u32 s3, s60, 1280
    s_cmp_lt_i32 s60, 0
    s_cselect_b32 s3, s3, s60
    s_min_u32 s3, s3, 1279
    s_lshl_b32 s45, s3, 17
    global_load_dword v212, v216, s[14:15]
    buffer_load_dwordx4 v[148:151], v2, s[24:27], s45 offen nt
    buffer_load_dwordx4 v[152:155], v3, s[24:27], s45 offen nt
    buffer_load_dwordx4 v[156:159], v4, s[24:27], s45 offen nt
    buffer_load_dwordx4 v[160:163], v5, s[24:27], s45 offen nt
    buffer_load_dwordx4 v[164:167], v2, s[28:31], s45 offen nt
    buffer_load_dwordx4 v[168:171], v3, s[28:31], s45 offen nt
    buffer_load_dwordx4 v[172:175], v4, s[28:31], s45 offen nt
    buffer_load_dwordx4 v[176:179], v5, s[28:31], s45 offen nt
    global_load_dword v80, v77, s[14:15]
    global_load_dwordx4 v[12:15], v71, s[8:9]
    global_load_dwordx4 v[16:19], v74, s[8:9]
    global_load_dwordx4 v[20:23], v75, s[8:9]
    global_load_dwordx4 v[24:27], v76, s[8:9]
    s_add_u32 s3, s61, 1280
    s_cmp_lt_i32 s61, 0
    s_cselect_b32 s3, s3, s61
    s_min_u32 s3, s3, 1279
    s_lshl_b32 s45, s3, 17
    global_load_dword v213, v216, s[14:15]
    buffer_load_dwordx4 v[180:183], v2, s[24:27], s45 offen nt
    buffer_load_dwordx4 v[184:187], v3, s[24:27], s45 offen nt
    buffer_load_dwordx4 v[188:191], v4, s[24:27], s45 offen nt
    buffer_load_dwordx4 v[192:195], v5, s[24:27], s45 offen nt
    buffer_load_dwordx4 v[196:199], v2, s[28:31], s45 offen nt
    buffer_load_dwordx4 v[200:203], v3, s[28:31], s45 offen nt
    buffer_load_dwordx4 v[204:207], v4, s[28:31], s45 offen nt
    buffer_load_dwordx4 v[208:211], v5, s[28:31], s45 offen nt
    v_mov_b32 v28, 0
    v_mov_b32 v29, 0
    v_mov_b32 v30, 0
    v_mov_b32 v31, 0
    v_mov_b32 v32, 0
    v_mov_b32 v33, 0
    v_mov_b32 v34, 0
    v_mov_b32 v35, 0
    v_mov_b32 v60, 0xf149f2ca
    v_mov_b32 v64, 0
    v_mov_b32 v36, 0
    v_mov_b32 v37, 0
    v_mov_b32 v38, 0
    v_mov_b32 v39, 0
    v_mov_b32 v40, 0
    v_mov_b32 v41, 0
    v_mov_b32 v42, 0
    v_mov_b32 v43, 0
    v_mov_b32 v61, 0xf149f2ca
    v_mov_b32 v65, 0
    v_mov_b32 v44, 0
    v_mov_b32 v45, 0
    v_mov_b32 v46, 0
    v_mov_b32 v47, 0
    v_mov_b32 v48, 0
    v_mov_b32 v49, 0
    v_mov_b32 v50, 0
    v_mov_b32 v51, 0
    v_mov_b32 v62, 0xf149f2ca
    v_mov_b32 v66, 0
    v_mov_b32 v52, 0
    v_mov_b32 v53, 0
    v_mov_b32 v54, 0
    v_mov_b32 v55, 0
    v_mov_b32 v56, 0
    v_mov_b32 v57, 0
    v_mov_b32 v58, 0
    v_mov_b32 v59, 0
    v_mov_b32 v63, 0xf149f2ca
    v_mov_b32 v67, 0
    s_mov_b32 s96, 0
    s_cmp_le_i32 s32, 0
    s_cselect_b32 s3, 1, 0
    s_cselect_b32 s32, 8192, s32
    s_or_b32 s96, s96, s3
    s_min_i32 s32, s32, 8192
    s_cmp_le_i32 s33, 0
    s_cselect_b32 s3, 2, 0
    s_cselect_b32 s33, 8192, s33
    s_or_b32 s96, s96, s3
    s_min_i32 s33, s33, 8192
    s_cmp_le_i32 s34, 0
    s_cselect_b32 s3, 4, 0
    s_cselect_b32 s34, 8192, s34
    s_or_b32 s96, s96, s3
    s_min_i32 s34, s34, 8192
    s_cmp_le_i32 s35, 0
    s_cselect_b32 s3, 8, 0
    s_cselect_b32 s35, 8192, s35
    s_or_b32 s96, s96, s3
    s_min_i32 s35, s35, 8192
    v_mov_b32 v82, s32
    s_mov_b32 exec_lo, 0x22222222
    s_mov_b32 exec_hi, 0x22222222
    v_mov_b32 v82, s33
    s_mov_b32 exec_lo, 0x44444444
    s_mov_b32 exec_hi, 0x44444444
    v_mov_b32 v82, s34
    s_mov_b32 exec_lo, 0x88888888
    s_mov_b32 exec_hi, 0x88888888
    v_mov_b32 v82, s35
    s_mov_b64 exec, -1
    v_lshlrev_b32 v10, 9, v78
    s_lshl_b32 s3, s38, 4
    v_add_u32 v10, s3, v10
    v_sub_u32 v83, v82, v10
    v_med3_i32 v83, v83, 0, 16
    v_lshlrev_b32 v11, 3, v79
    v_lshlrev_b32 v83, v11, v83
    v_lshrrev_b32 v10, 1, v10
    s_mov_b32 s51, 0x1000
    s_mov_b32 s42, 0x1000
    s_mov_b32 s64, -1
    s_mov_b32 s71, 6
    s_mov_b32 s65, 0
    s_mov_b32 s66, 0
    s_mov_b32 s72, -1
    s_mov_b32 s67, 0
    s_mov_b32 s41, 0
    s_mov_b32 s43, 0
    s_waitcnt vmcnt(9)
    v_cmp_gt_i32 vcc, 0, v80
    v_add_u32 v11, 1280, v80
    s_nop 0
    v_cndmask_b32 v80, v80, v11, vcc
    v_min_u32 v80, 1279, v80
    s_nop 1
    v_mov_b32_dpp v11, v80 quad_perm:[0,0,0,0] row_mask:0xf bank_mask:0xf
    v_cmp_eq_u32 vcc, v80, v11
    s_nop 1
    v_cndmask_b32 v81, 0, v83, vcc
    v_lshlrev_b32 v80, 17, v11
    v_cmp_ne_u32 vcc, 0, v81
    s_nop 0
    s_and_b32 vcc_lo, vcc_lo, 0xeeeeeeee
    s_and_b32 vcc_hi, vcc_hi, 0xeeeeeeee
    v_mov_b32 v11, 128
    v_cndmask_b32 v11, 0, v11, vcc
    v_or_b32 v81, v81, v11
    s_nop 1
    v_or_b32_dpp v81, v81, v81 quad_perm:[1,0,3,2] row_mask:0xf bank_mask:0xf
    s_nop 1
    v_or_b32_dpp v81, v81, v81 quad_perm:[2,3,0,1] row_mask:0xf bank_mask:0xf
    s_min_u32 s3, s96, 1
    s_cmp_eq_u32 s3, 0
    s_cbranch_scc1 L_qok
    s_bitcmp0_b32 s96, 0
    s_cbranch_scc1 L_qz_1
    v_mov_b32 v12, 0
    v_mov_b32 v13, 0
    v_mov_b32 v14, 0
    v_mov_b32 v15, 0
L_qz_1:
    s_bitcmp0_b32 s96, 1
    s_cbranch_scc1 L_qz_2
    v_mov_b32 v16, 0
    v_mov_b32 v17, 0
    v_mov_b32 v18, 0
    v_mov_b32 v19, 0
L_qz_2:
    s_bitcmp0_b32 s96, 2
    s_cbranch_scc1 L_qz_3
    v_mov_b32 v20, 0
    v_mov_b32 v21, 0
    v_mov_b32 v22, 0
    v_mov_b32 v23, 0
L_qz_3:
    s_bitcmp0_b32 s96, 3
    s_cbranch_scc1 L_qz_4
    v_mov_b32 v24, 0
    v_mov_b32 v25, 0
    v_mov_b32 v26, 0
    v_mov_b32 v27, 0
L_qz_4:
L_qok:
    s_cmp_lt_u32 s32, 4096
    s_cbranch_scc1 L_slowstart
    s_mov_b32 exec_lo, 0x11111111
    s_mov_b32 exec_hi, 0
    ds_write_b64 v10, v[80:81] offset:256
    s_mov_b64 exec, -1
    v_readlane_b32 s60, v81, 0
    v_readlane_b32 s61, v81, 4
L_loop:
    s_cmp_eq_u32 s43, 1
    s_nop 2
    s_cbranch_scc1 L_st1
L_st0:
    s_cmp_eq_u32 s60, 0
    s_cbranch_scc1 L_done
    s_add_u32 s3, s41, 2
    s_lshl_b32 s69, s3, 5
    s_add_u32 s69, s69, s38
    s_waitcnt vmcnt(8)
    v_readfirstlane_b32 s70, v213
    s_nop 0
    s_add_u32 s4, s70, s65
    s_cmp_lt_u32 s3, s51
    s_cselect_b32 s69, s69, s4
    s_cmp_ge_u32 s41, s72
    s_cselect_b32 s69, -1, s69
    s_cmp_lt_u32 s69, s42
    s_cselect_b32 s4, s69, 0
    s_cselect_b32 s66, s66, 1
    s_cselect_b32 s26, 0xa000000, 0
    s_add_u32 s5, s41, 1
    s_cmp_lg_u32 s66, 0
    s_cselect_b32 s5, s5, -1
    s_min_u32 s72, s72, s5
    s_mov_b32 s30, s26
    s_lshl_b32 s4, s4, 3
    v_mov_b32 v10, s4
    ds_read_b64 v[10:11], v10 offset:256
    v_mov_b64 v[116:117], v[148:149]
    v_mov_b64 v[118:119], v[150:151]
    v_mov_b64 v[120:121], v[152:153]
    v_mov_b64 v[122:123], v[154:155]
    v_mov_b64 v[124:125], v[156:157]
    v_mov_b64 v[126:127], v[158:159]
    v_mov_b64 v[128:129], v[160:161]
    v_mov_b64 v[130:131], v[162:163]
    v_mov_b64 v[132:133], v[164:165]
    v_mov_b64 v[134:135], v[166:167]
    v_mov_b64 v[136:137], v[168:169]
    v_mov_b64 v[138:139], v[170:171]
    v_mov_b64 v[140:141], v[172:173]
    v_mov_b64 v[142:143], v[174:175]
    v_mov_b64 v[144:145], v[176:177]
    v_mov_b64 v[146:147], v[178:179]
    s_cmp_ge_u32 s41, s64
    s_cbranch_scc0 L_nocl0
    s_cmp_lg_u32 s66, 0
    s_cbranch_scc1 L_dum0
    s_cmp_lg_u32 s67, 0
    s_cbranch_scc1 L_cl0
    s_lshr_b32 s4, s70, 16
    s_cmp_lg_u32 s4, 0
    s_cbranch_scc0 L_elect
    s_mov_b32 s67, 1
L_cl0:
    s_mov_b64 exec, 1
    global_atomic_add v212, v8, v9, s[22:23] sc0
    s_mov_b64 exec, -1
    s_branch L_iss0
L_nocl0:
    s_cmp_eq_u32 s41, s71
    s_cbranch_scc0 L_dum0
    s_cmp_eq_u32 s42, 0x1000
    s_cbranch_scc1 L_getconst
    s_mov_b64 exec, 1
    global_load_dword v212, v214, s[20:21] sc1
    s_mov_b64 exec, -1
    s_branch L_iss0
L_dum0:
    global_load_dword v212, v216, s[14:15]
L_iss0:
    s_waitcnt lgkmcnt(0)
    v_readfirstlane_b32 s45, v10
    v_readfirstlane_b32 s68, v11
    s_cmp_lg_u32 s26, 0
    s_cselect_b32 s68, s68, 0
    s_cselect_b32 s45, s45, 0
    s_nop 0
    buffer_load_dwordx4 v[148:151], v2, s[24:27], s45 offen nt
    buffer_load_dwordx4 v[152:155], v3, s[24:27], s45 offen nt
    buffer_load_dwordx4 v[156:159], v4, s[24:27], s45 offen nt
    buffer_load_dwordx4 v[160:163], v5, s[24:27], s45 offen nt
    buffer_load_dwordx4 v[164:167], v2, s[28:31], s45 offen nt
    buffer_load_dwordx4 v[168:171], v3, s[28:31], s45 offen nt
    buffer_load_dwordx4 v[172:175], v4, s[28:31], s45 offen nt
    buffer_load_dwordx4 v[176:179], v5, s[28:31], s45 offen nt
    s_mov_b32 s44, s60
    s_mov_b32 s60, s68
    s_mov_b32 s43, 1
    s_branch L_comp
L_st1:
    s_cmp_eq_u32 s61, 0
    s_cbranch_scc1 L_done
    s_add_u32 s3, s41, 2
    s_lshl_b32 s69, s3, 5
    s_add_u32 s69, s69, s38
    s_waitcnt vmcnt(8)
    v_readfirstlane_b32 s70, v212
    s_nop 0
    s_add_u32 s4, s70, s65
    s_cmp_lt_u32 s3, s51
    s_cselect_b32 s69, s69, s4
    s_cmp_ge_u32 s41, s72
    s_cselect_b32 s69, -1, s69
    s_cmp_lt_u32 s69, s42
    s_cselect_b32 s4, s69, 0
    s_cselect_b32 s66, s66, 1
    s_cselect_b32 s26, 0xa000000, 0
    s_add_u32 s5, s41, 1
    s_cmp_lg_u32 s66, 0
    s_cselect_b32 s5, s5, -1
    s_min_u32 s72, s72, s5
    s_mov_b32 s30, s26
    s_lshl_b32 s4, s4, 3
    v_mov_b32 v10, s4
    ds_read_b64 v[10:11], v10 offset:256
    v_mov_b64 v[116:117], v[180:181]
    v_mov_b64 v[118:119], v[182:183]
    v_mov_b64 v[120:121], v[184:185]
    v_mov_b64 v[122:123], v[186:187]
    v_mov_b64 v[124:125], v[188:189]
    v_mov_b64 v[126:127], v[190:191]
    v_mov_b64 v[128:129], v[192:193]
    v_mov_b64 v[130:131], v[194:195]
    v_mov_b64 v[132:133], v[196:197]
    v_mov_b64 v[134:135], v[198:199]
    v_mov_b64 v[136:137], v[200:201]
    v_mov_b64 v[138:139], v[202:203]
    v_mov_b64 v[140:141], v[204:205]
    v_mov_b64 v[142:143], v[206:207]
    v_mov_b64 v[144:145], v[208:209]
    v_mov_b64 v[146:147], v[210:211]
    s_cmp_ge_u32 s41, s64
    s_cbranch_scc0 L_nocl1
    s_cmp_lg_u32 s66, 0
    s_cbranch_scc1 L_dum1
    s_cmp_lg_u32 s67, 0
    s_cbranch_scc1 L_cl1
    s_lshr_b32 s4, s70, 16
    s_cmp_lg_u32 s4, 0
    s_cbranch_scc0 L_elect
    s_mov_b32 s67, 1
L_cl1:
    s_mov_b64 exec, 1
    global_atomic_add v213, v8, v9, s[22:23] sc0
    s_mov_b64 exec, -1
    s_branch L_iss1
L_nocl1:
    s_cmp_eq_u32 s41, s71
    s_cbranch_scc0 L_dum1
    s_cmp_eq_u32 s42, 0x1000
    s_cbranch_scc1 L_getconst
    s_mov_b64 exec, 1
    global_load_dword v213, v214, s[20:21] sc1
    s_mov_b64 exec, -1
    s_branch L_iss1
L_dum1:
    global_load_dword v213, v216, s[14:15]
L_iss1:
    s_waitcnt lgkmcnt(0)
    v_readfirstlane_b32 s45, v10
    v_readfirstlane_b32 s68, v11
    s_cmp_lg_u32 s26, 0
    s_cselect_b32 s68, s68, 0
    s_cselect_b32 s45, s45, 0
    s_nop 0
    buffer_load_dwordx4 v[180:183], v2, s[24:27], s45 offen nt
    buffer_load_dwordx4 v[184:187], v3, s[24:27], s45 offen nt
    buffer_load_dwordx4 v[188:191], v4, s[24:27], s45 offen nt
    buffer_load_dwordx4 v[192:195], v5, s[24:27], s45 offen nt
    buffer_load_dwordx4 v[196:199], v2, s[28:31], s45 offen nt
    buffer_load_dwordx4 v[200:203], v3, s[28:31], s45 offen nt
    buffer_load_dwordx4 v[204:207], v4, s[28:31], s45 offen nt
    buffer_load_dwordx4 v[208:211], v5, s[28:31], s45 offen nt
    s_mov_b32 s44, s61
    s_mov_b32 s61, s68
    s_mov_b32 s43, 0
L_comp:
    s_bfe_u32 s50, s44, 0x30005
    s_bfe_u32 s46, s44, 0x50000
    s_bfe_u32 s47, s44, 0x50008
    s_bfe_u32 s48, s44, 0x50010
    s_bfe_u32 s49, s44, 0x50018
    s_cmp_eq_u32 s50, 4
    s_cbranch_scc1 L_c4
    s_cmp_eq_u32 s50, 1
    s_cbranch_scc1 L_c1
    s_cmp_eq_u32 s50, 2
    s_cbranch_scc1 L_c2
    s_cmp_eq_u32 s50, 3
    s_cbranch_scc1 L_c3
L_c0:
    v_cmp_gt_u32 s[52:53], s46, v6
    v_dot2_f32_bf16 v68, v116, v12, 0
    v_dot2_f32_bf16 v69, v120, v12, 0
    v_dot2_f32_bf16 v70, v124, v12, 0
    v_dot2_f32_bf16 v71, v128, v12, 0
    v_dot2c_f32_bf16 v68, v117, v13
    v_dot2c_f32_bf16 v69, v121, v13
    v_dot2c_f32_bf16 v70, v125, v13
    v_dot2c_f32_bf16 v71, v129, v13
    v_dot2c_f32_bf16 v68, v118, v14
    v_dot2c_f32_bf16 v69, v122, v14
    v_dot2c_f32_bf16 v70, v126, v14
    v_dot2c_f32_bf16 v71, v130, v14
    v_dot2c_f32_bf16 v68, v119, v15
    v_dot2c_f32_bf16 v69, v123, v15
    v_dot2c_f32_bf16 v70, v127, v15
    v_dot2c_f32_bf16 v71, v131, v15
    v_lshlrev_b32 v100, 16, v132
    v_and_b32 v101, s40, v132
    v_lshlrev_b32 v102, 16, v133
    v_and_b32 v103, s40, v133
    v_lshlrev_b32 v104, 16, v134
    v_and_b32 v105, s40, v134
    v_lshlrev_b32 v106, 16, v135
    v_and_b32 v107, s40, v135
    v_add_f32_dpp v68, v68, v68 row_ror:8 row_mask:0xf bank_mask:0x3
    v_add_f32_dpp v69, v69, v69 row_ror:8 row_mask:0xf bank_mask:0x3
    s_nop 0
    v_add_f32_dpp v68, v70, v70 row_ror:8 row_mask:0xf bank_mask:0xc
    v_add_f32_dpp v69, v71, v71 row_ror:8 row_mask:0xf bank_mask:0xc
    v_lshlrev_b32 v108, 16, v136
    v_and_b32 v109, s40, v136
    v_lshlrev_b32 v110, 16, v137
    v_and_b32 v111, s40, v137
    v_lshlrev_b32 v112, 16, v138
    v_and_b32 v113, s40, v138
    v_lshlrev_b32 v114, 16, v139
    v_and_b32 v115, s40, v139
    v_add_f32_dpp v68, v68, v68 row_half_mirror row_mask:0xf bank_mask:0x5
    s_nop 1
    v_add_f32_dpp v68, v69, v69 row_half_mirror row_mask:0xf bank_mask:0xa
    s_nop 1
    v_add_f32_dpp v68, v68, v68 quad_perm:[1,0,3,2] row_mask:0xf bank_mask:0xf
    s_nop 1
    v_add_f32_dpp v68, v68, v68 quad_perm:[2,3,0,1] row_mask:0xf bank_mask:0xf
    v_mul_f32 v68, s39, v68
    v_cndmask_b32 v68, v7, v68, s[52:53]
    v_max_f32 v93, v68, v60
    s_nop 1
    v_max_f32_dpp v93, v93, v93 row_ror:4 row_mask:0xf bank_mask:0xf
    s_nop 1
    v_max_f32_dpp v93, v93, v93 row_ror:8 row_mask:0xf bank_mask:0xf
    v_sub_f32 v84, v60, v93
    v_sub_f32 v85, v68, v93
    v_exp_f32 v84, v84
    v_exp_f32 v85, v85
    v_mov_b32 v60, v93
    v_fma_f32 v64, v64, v84, v85
    v_pk_mul_f32 v[28:29], v[28:29], v[84:85] op_sel_hi:[1,0]
    v_pk_mul_f32 v[30:31], v[30:31], v[84:85] op_sel_hi:[1,0]
    v_pk_mul_f32 v[32:33], v[32:33], v[84:85] op_sel_hi:[1,0]
    v_pk_mul_f32 v[34:35], v[34:35], v[84:85] op_sel_hi:[1,0]
    v_mov_b32_dpp v92, v85 row_newbcast:0 row_mask:0xf bank_mask:0xf
    v_pk_fma_f32 v[28:29], v[100:101], v[92:93], v[28:29] op_sel_hi:[1,0,1]
    v_pk_fma_f32 v[30:31], v[102:103], v[92:93], v[30:31] op_sel_hi:[1,0,1]
    v_pk_fma_f32 v[32:33], v[104:105], v[92:93], v[32:33] op_sel_hi:[1,0,1]
    v_pk_fma_f32 v[34:35], v[106:107], v[92:93], v[34:35] op_sel_hi:[1,0,1]
    v_lshlrev_b32 v100, 16, v140
    v_and_b32 v101, s40, v140
    v_lshlrev_b32 v102, 16, v141
    v_and_b32 v103, s40, v141
    v_lshlrev_b32 v104, 16, v142
    v_and_b32 v105, s40, v142
    v_lshlrev_b32 v106, 16, v143
    v_and_b32 v107, s40, v143
    v_mov_b32_dpp v92, v85 row_newbcast:4 row_mask:0xf bank_mask:0xf
    v_pk_fma_f32 v[28:29], v[108:109], v[92:93], v[28:29] op_sel_hi:[1,0,1]
    v_pk_fma_f32 v[30:31], v[110:111], v[92:93], v[30:31] op_sel_hi:[1,0,1]
    v_pk_fma_f32 v[32:33], v[112:113], v[92:93], v[32:33] op_sel_hi:[1,0,1]
    v_pk_fma_f32 v[34:35], v[114:115], v[92:93], v[34:35] op_sel_hi:[1,0,1]
    v_lshlrev_b32 v108, 16, v144
    v_and_b32 v109, s40, v144
    v_lshlrev_b32 v110, 16, v145
    v_and_b32 v111, s40, v145
    v_lshlrev_b32 v112, 16, v146
    v_and_b32 v113, s40, v146
    v_lshlrev_b32 v114, 16, v147
    v_and_b32 v115, s40, v147
    v_mov_b32_dpp v92, v85 row_newbcast:8 row_mask:0xf bank_mask:0xf
    v_pk_fma_f32 v[28:29], v[100:101], v[92:93], v[28:29] op_sel_hi:[1,0,1]
    v_pk_fma_f32 v[30:31], v[102:103], v[92:93], v[30:31] op_sel_hi:[1,0,1]
    v_pk_fma_f32 v[32:33], v[104:105], v[92:93], v[32:33] op_sel_hi:[1,0,1]
    v_pk_fma_f32 v[34:35], v[106:107], v[92:93], v[34:35] op_sel_hi:[1,0,1]
    v_mov_b32_dpp v92, v85 row_newbcast:12 row_mask:0xf bank_mask:0xf
    v_pk_fma_f32 v[28:29], v[108:109], v[92:93], v[28:29] op_sel_hi:[1,0,1]
    v_pk_fma_f32 v[30:31], v[110:111], v[92:93], v[30:31] op_sel_hi:[1,0,1]
    v_pk_fma_f32 v[32:33], v[112:113], v[92:93], v[32:33] op_sel_hi:[1,0,1]
    v_pk_fma_f32 v[34:35], v[114:115], v[92:93], v[34:35] op_sel_hi:[1,0,1]
    s_nop 0
    s_branch L_next
L_c1:
    v_cmp_gt_u32 s[52:53], s47, v6
    v_dot2_f32_bf16 v68, v116, v16, 0
    v_dot2_f32_bf16 v69, v120, v16, 0
    v_dot2_f32_bf16 v70, v124, v16, 0
    v_dot2_f32_bf16 v71, v128, v16, 0
    v_dot2c_f32_bf16 v68, v117, v17
    v_dot2c_f32_bf16 v69, v121, v17
    v_dot2c_f32_bf16 v70, v125, v17
    v_dot2c_f32_bf16 v71, v129, v17
    v_dot2c_f32_bf16 v68, v118, v18
    v_dot2c_f32_bf16 v69, v122, v18
    v_dot2c_f32_bf16 v70, v126, v18
    v_dot2c_f32_bf16 v71, v130, v18
    v_dot2c_f32_bf16 v68, v119, v19
    v_dot2c_f32_bf16 v69, v123, v19
    v_dot2c_f32_bf16 v70, v127, v19
    v_dot2c_f32_bf16 v71, v131, v19
    v_lshlrev_b32 v100, 16, v132
    v_and_b32 v101, s40, v132
    v_lshlrev_b32 v102, 16, v133
    v_and_b32 v103, s40, v133
    v_lshlrev_b32 v104, 16, v134
    v_and_b32 v105, s40, v134
    v_lshlrev_b32 v106, 16, v135
    v_and_b32 v107, s40, v135
    v_add_f32_dpp v68, v68, v68 row_ror:8 row_mask:0xf bank_mask:0x3
    v_add_f32_dpp v69, v69, v69 row_ror:8 row_mask:0xf bank_mask:0x3
    s_nop 0
    v_add_f32_dpp v68, v70, v70 row_ror:8 row_mask:0xf bank_mask:0xc
    v_add_f32_dpp v69, v71, v71 row_ror:8 row_mask:0xf bank_mask:0xc
    v_lshlrev_b32 v108, 16, v136
    v_and_b32 v109, s40, v136
    v_lshlrev_b32 v110, 16, v137
    v_and_b32 v111, s40, v137
    v_lshlrev_b32 v112, 16, v138
    v_and_b32 v113, s40, v138
    v_lshlrev_b32 v114, 16, v139
    v_and_b32 v115, s40, v139
    v_add_f32_dpp v68, v68, v68 row_half_mirror row_mask:0xf bank_mask:0x5
    s_nop 1
    v_add_f32_dpp v68, v69, v69 row_half_mirror row_mask:0xf bank_mask:0xa
    s_nop 1
    v_add_f32_dpp v68, v68, v68 quad_perm:[1,0,3,2] row_mask:0xf bank_mask:0xf
    s_nop 1
    v_add_f32_dpp v68, v68, v68 quad_perm:[2,3,0,1] row_mask:0xf bank_mask:0xf
    v_mul_f32 v68, s39, v68
    v_cndmask_b32 v68, v7, v68, s[52:53]
    v_max_f32 v93, v68, v61
    s_nop 1
    v_max_f32_dpp v93, v93, v93 row_ror:4 row_mask:0xf bank_mask:0xf
    s_nop 1
    v_max_f32_dpp v93, v93, v93 row_ror:8 row_mask:0xf bank_mask:0xf
    v_sub_f32 v84, v61, v93
    v_sub_f32 v85, v68, v93
    v_exp_f32 v84, v84
    v_exp_f32 v85, v85
    v_mov_b32 v61, v93
    v_fma_f32 v65, v65, v84, v85
    v_pk_mul_f32 v[36:37], v[36:37], v[84:85] op_sel_hi:[1,0]
    v_pk_mul_f32 v[38:39], v[38:39], v[84:85] op_sel_hi:[1,0]
    v_pk_mul_f32 v[40:41], v[40:41], v[84:85] op_sel_hi:[1,0]
    v_pk_mul_f32 v[42:43], v[42:43], v[84:85] op_sel_hi:[1,0]
    v_mov_b32_dpp v92, v85 row_newbcast:0 row_mask:0xf bank_mask:0xf
    v_pk_fma_f32 v[36:37], v[100:101], v[92:93], v[36:37] op_sel_hi:[1,0,1]
    v_pk_fma_f32 v[38:39], v[102:103], v[92:93], v[38:39] op_sel_hi:[1,0,1]
    v_pk_fma_f32 v[40:41], v[104:105], v[92:93], v[40:41] op_sel_hi:[1,0,1]
    v_pk_fma_f32 v[42:43], v[106:107], v[92:93], v[42:43] op_sel_hi:[1,0,1]
    v_lshlrev_b32 v100, 16, v140
    v_and_b32 v101, s40, v140
    v_lshlrev_b32 v102, 16, v141
    v_and_b32 v103, s40, v141
    v_lshlrev_b32 v104, 16, v142
    v_and_b32 v105, s40, v142
    v_lshlrev_b32 v106, 16, v143
    v_and_b32 v107, s40, v143
    v_mov_b32_dpp v92, v85 row_newbcast:4 row_mask:0xf bank_mask:0xf
    v_pk_fma_f32 v[36:37], v[108:109], v[92:93], v[36:37] op_sel_hi:[1,0,1]
    v_pk_fma_f32 v[38:39], v[110:111], v[92:93], v[38:39] op_sel_hi:[1,0,1]
    v_pk_fma_f32 v[40:41], v[112:113], v[92:93], v[40:41] op_sel_hi:[1,0,1]
    v_pk_fma_f32 v[42:43], v[114:115], v[92:93], v[42:43] op_sel_hi:[1,0,1]
    v_lshlrev_b32 v108, 16, v144
    v_and_b32 v109, s40, v144
    v_lshlrev_b32 v110, 16, v145
    v_and_b32 v111, s40, v145
    v_lshlrev_b32 v112, 16, v146
    v_and_b32 v113, s40, v146
    v_lshlrev_b32 v114, 16, v147
    v_and_b32 v115, s40, v147
    v_mov_b32_dpp v92, v85 row_newbcast:8 row_mask:0xf bank_mask:0xf
    v_pk_fma_f32 v[36:37], v[100:101], v[92:93], v[36:37] op_sel_hi:[1,0,1]
    v_pk_fma_f32 v[38:39], v[102:103], v[92:93], v[38:39] op_sel_hi:[1,0,1]
    v_pk_fma_f32 v[40:41], v[104:105], v[92:93], v[40:41] op_sel_hi:[1,0,1]
    v_pk_fma_f32 v[42:43], v[106:107], v[92:93], v[42:43] op_sel_hi:[1,0,1]
    v_mov_b32_dpp v92, v85 row_newbcast:12 row_mask:0xf bank_mask:0xf
    v_pk_fma_f32 v[36:37], v[108:109], v[92:93], v[36:37] op_sel_hi:[1,0,1]
    v_pk_fma_f32 v[38:39], v[110:111], v[92:93], v[38:39] op_sel_hi:[1,0,1]
    v_pk_fma_f32 v[40:41], v[112:113], v[92:93], v[40:41] op_sel_hi:[1,0,1]
    v_pk_fma_f32 v[42:43], v[114:115], v[92:93], v[42:43] op_sel_hi:[1,0,1]
    s_nop 0
    s_branch L_next
L_c2:
    v_cmp_gt_u32 s[52:53], s48, v6
    v_dot2_f32_bf16 v68, v116, v20, 0
    v_dot2_f32_bf16 v69, v120, v20, 0
    v_dot2_f32_bf16 v70, v124, v20, 0
    v_dot2_f32_bf16 v71, v128, v20, 0
    v_dot2c_f32_bf16 v68, v117, v21
    v_dot2c_f32_bf16 v69, v121, v21
    v_dot2c_f32_bf16 v70, v125, v21
    v_dot2c_f32_bf16 v71, v129, v21
    v_dot2c_f32_bf16 v68, v118, v22
    v_dot2c_f32_bf16 v69, v122, v22
    v_dot2c_f32_bf16 v70, v126, v22
    v_dot2c_f32_bf16 v71, v130, v22
    v_dot2c_f32_bf16 v68, v119, v23
    v_dot2c_f32_bf16 v69, v123, v23
    v_dot2c_f32_bf16 v70, v127, v23
    v_dot2c_f32_bf16 v71, v131, v23
    v_lshlrev_b32 v100, 16, v132
    v_and_b32 v101, s40, v132
    v_lshlrev_b32 v102, 16, v133
    v_and_b32 v103, s40, v133
    v_lshlrev_b32 v104, 16, v134
    v_and_b32 v105, s40, v134
    v_lshlrev_b32 v106, 16, v135
    v_and_b32 v107, s40, v135
    v_add_f32_dpp v68, v68, v68 row_ror:8 row_mask:0xf bank_mask:0x3
    v_add_f32_dpp v69, v69, v69 row_ror:8 row_mask:0xf bank_mask:0x3
    s_nop 0
    v_add_f32_dpp v68, v70, v70 row_ror:8 row_mask:0xf bank_mask:0xc
    v_add_f32_dpp v69, v71, v71 row_ror:8 row_mask:0xf bank_mask:0xc
    v_lshlrev_b32 v108, 16, v136
    v_and_b32 v109, s40, v136
    v_lshlrev_b32 v110, 16, v137
    v_and_b32 v111, s40, v137
    v_lshlrev_b32 v112, 16, v138
    v_and_b32 v113, s40, v138
    v_lshlrev_b32 v114, 16, v139
    v_and_b32 v115, s40, v139
    v_add_f32_dpp v68, v68, v68 row_half_mirror row_mask:0xf bank_mask:0x5
    s_nop 1
    v_add_f32_dpp v68, v69, v69 row_half_mirror row_mask:0xf bank_mask:0xa
    s_nop 1
    v_add_f32_dpp v68, v68, v68 quad_perm:[1,0,3,2] row_mask:0xf bank_mask:0xf
    s_nop 1
    v_add_f32_dpp v68, v68, v68 quad_perm:[2,3,0,1] row_mask:0xf bank_mask:0xf
    v_mul_f32 v68, s39, v68
    v_cndmask_b32 v68, v7, v68, s[52:53]
    v_max_f32 v93, v68, v62
    s_nop 1
    v_max_f32_dpp v93, v93, v93 row_ror:4 row_mask:0xf bank_mask:0xf
    s_nop 1
    v_max_f32_dpp v93, v93, v93 row_ror:8 row_mask:0xf bank_mask:0xf
    v_sub_f32 v84, v62, v93
    v_sub_f32 v85, v68, v93
    v_exp_f32 v84, v84
    v_exp_f32 v85, v85
    v_mov_b32 v62, v93
    v_fma_f32 v66, v66, v84, v85
    v_pk_mul_f32 v[44:45], v[44:45], v[84:85] op_sel_hi:[1,0]
    v_pk_mul_f32 v[46:47], v[46:47], v[84:85] op_sel_hi:[1,0]
    v_pk_mul_f32 v[48:49], v[48:49], v[84:85] op_sel_hi:[1,0]
    v_pk_mul_f32 v[50:51], v[50:51], v[84:85] op_sel_hi:[1,0]
    v_mov_b32_dpp v92, v85 row_newbcast:0 row_mask:0xf bank_mask:0xf
    v_pk_fma_f32 v[44:45], v[100:101], v[92:93], v[44:45] op_sel_hi:[1,0,1]
    v_pk_fma_f32 v[46:47], v[102:103], v[92:93], v[46:47] op_sel_hi:[1,0,1]
    v_pk_fma_f32 v[48:49], v[104:105], v[92:93], v[48:49] op_sel_hi:[1,0,1]
    v_pk_fma_f32 v[50:51], v[106:107], v[92:93], v[50:51] op_sel_hi:[1,0,1]
    v_lshlrev_b32 v100, 16, v140
    v_and_b32 v101, s40, v140
    v_lshlrev_b32 v102, 16, v141
    v_and_b32 v103, s40, v141
    v_lshlrev_b32 v104, 16, v142
    v_and_b32 v105, s40, v142
    v_lshlrev_b32 v106, 16, v143
    v_and_b32 v107, s40, v143
    v_mov_b32_dpp v92, v85 row_newbcast:4 row_mask:0xf bank_mask:0xf
    v_pk_fma_f32 v[44:45], v[108:109], v[92:93], v[44:45] op_sel_hi:[1,0,1]
    v_pk_fma_f32 v[46:47], v[110:111], v[92:93], v[46:47] op_sel_hi:[1,0,1]
    v_pk_fma_f32 v[48:49], v[112:113], v[92:93], v[48:49] op_sel_hi:[1,0,1]
    v_pk_fma_f32 v[50:51], v[114:115], v[92:93], v[50:51] op_sel_hi:[1,0,1]
    v_lshlrev_b32 v108, 16, v144
    v_and_b32 v109, s40, v144
    v_lshlrev_b32 v110, 16, v145
    v_and_b32 v111, s40, v145
    v_lshlrev_b32 v112, 16, v146
    v_and_b32 v113, s40, v146
    v_lshlrev_b32 v114, 16, v147
    v_and_b32 v115, s40, v147
    v_mov_b32_dpp v92, v85 row_newbcast:8 row_mask:0xf bank_mask:0xf
    v_pk_fma_f32 v[44:45], v[100:101], v[92:93], v[44:45] op_sel_hi:[1,0,1]
    v_pk_fma_f32 v[46:47], v[102:103], v[92:93], v[46:47] op_sel_hi:[1,0,1]
    v_pk_fma_f32 v[48:49], v[104:105], v[92:93], v[48:49] op_sel_hi:[1,0,1]
    v_pk_fma_f32 v[50:51], v[106:107], v[92:93], v[50:51] op_sel_hi:[1,0,1]
    v_mov_b32_dpp v92, v85 row_newbcast:12 row_mask:0xf bank_mask:0xf
    v_pk_fma_f32 v[44:45], v[108:109], v[92:93], v[44:45] op_sel_hi:[1,0,1]
    v_pk_fma_f32 v[46:47], v[110:111], v[92:93], v[46:47] op_sel_hi:[1,0,1]
    v_pk_fma_f32 v[48:49], v[112:113], v[92:93], v[48:49] op_sel_hi:[1,0,1]
    v_pk_fma_f32 v[50:51], v[114:115], v[92:93], v[50:51] op_sel_hi:[1,0,1]
    s_nop 0
    s_branch L_next
L_c3:
    v_cmp_gt_u32 s[52:53], s49, v6
    v_dot2_f32_bf16 v68, v116, v24, 0
    v_dot2_f32_bf16 v69, v120, v24, 0
    v_dot2_f32_bf16 v70, v124, v24, 0
    v_dot2_f32_bf16 v71, v128, v24, 0
    v_dot2c_f32_bf16 v68, v117, v25
    v_dot2c_f32_bf16 v69, v121, v25
    v_dot2c_f32_bf16 v70, v125, v25
    v_dot2c_f32_bf16 v71, v129, v25
    v_dot2c_f32_bf16 v68, v118, v26
    v_dot2c_f32_bf16 v69, v122, v26
    v_dot2c_f32_bf16 v70, v126, v26
    v_dot2c_f32_bf16 v71, v130, v26
    v_dot2c_f32_bf16 v68, v119, v27
    v_dot2c_f32_bf16 v69, v123, v27
    v_dot2c_f32_bf16 v70, v127, v27
    v_dot2c_f32_bf16 v71, v131, v27
    v_lshlrev_b32 v100, 16, v132
    v_and_b32 v101, s40, v132
    v_lshlrev_b32 v102, 16, v133
    v_and_b32 v103, s40, v133
    v_lshlrev_b32 v104, 16, v134
    v_and_b32 v105, s40, v134
    v_lshlrev_b32 v106, 16, v135
    v_and_b32 v107, s40, v135
    v_add_f32_dpp v68, v68, v68 row_ror:8 row_mask:0xf bank_mask:0x3
    v_add_f32_dpp v69, v69, v69 row_ror:8 row_mask:0xf bank_mask:0x3
    s_nop 0
    v_add_f32_dpp v68, v70, v70 row_ror:8 row_mask:0xf bank_mask:0xc
    v_add_f32_dpp v69, v71, v71 row_ror:8 row_mask:0xf bank_mask:0xc
    v_lshlrev_b32 v108, 16, v136
    v_and_b32 v109, s40, v136
    v_lshlrev_b32 v110, 16, v137
    v_and_b32 v111, s40, v137
    v_lshlrev_b32 v112, 16, v138
    v_and_b32 v113, s40, v138
    v_lshlrev_b32 v114, 16, v139
    v_and_b32 v115, s40, v139
    v_add_f32_dpp v68, v68, v68 row_half_mirror row_mask:0xf bank_mask:0x5
    s_nop 1
    v_add_f32_dpp v68, v69, v69 row_half_mirror row_mask:0xf bank_mask:0xa
    s_nop 1
    v_add_f32_dpp v68, v68, v68 quad_perm:[1,0,3,2] row_mask:0xf bank_mask:0xf
    s_nop 1
    v_add_f32_dpp v68, v68, v68 quad_perm:[2,3,0,1] row_mask:0xf bank_mask:0xf
    v_mul_f32 v68, s39, v68
    v_cndmask_b32 v68, v7, v68, s[52:53]
    v_max_f32 v93, v68, v63
    s_nop 1
    v_max_f32_dpp v93, v93, v93 row_ror:4 row_mask:0xf bank_mask:0xf
    s_nop 1
    v_max_f32_dpp v93, v93, v93 row_ror:8 row_mask:0xf bank_mask:0xf
    v_sub_f32 v84, v63, v93
    v_sub_f32 v85, v68, v93
    v_exp_f32 v84, v84
    v_exp_f32 v85, v85
    v_mov_b32 v63, v93
    v_fma_f32 v67, v67, v84, v85
    v_pk_mul_f32 v[52:53], v[52:53], v[84:85] op_sel_hi:[1,0]
    v_pk_mul_f32 v[54:55], v[54:55], v[84:85] op_sel_hi:[1,0]
    v_pk_mul_f32 v[56:57], v[56:57], v[84:85] op_sel_hi:[1,0]
    v_pk_mul_f32 v[58:59], v[58:59], v[84:85] op_sel_hi:[1,0]
    v_mov_b32_dpp v92, v85 row_newbcast:0 row_mask:0xf bank_mask:0xf
    v_pk_fma_f32 v[52:53], v[100:101], v[92:93], v[52:53] op_sel_hi:[1,0,1]
    v_pk_fma_f32 v[54:55], v[102:103], v[92:93], v[54:55] op_sel_hi:[1,0,1]
    v_pk_fma_f32 v[56:57], v[104:105], v[92:93], v[56:57] op_sel_hi:[1,0,1]
    v_pk_fma_f32 v[58:59], v[106:107], v[92:93], v[58:59] op_sel_hi:[1,0,1]
    v_lshlrev_b32 v100, 16, v140
    v_and_b32 v101, s40, v140
    v_lshlrev_b32 v102, 16, v141
    v_and_b32 v103, s40, v141
    v_lshlrev_b32 v104, 16, v142
    v_and_b32 v105, s40, v142
    v_lshlrev_b32 v106, 16, v143
    v_and_b32 v107, s40, v143
    v_mov_b32_dpp v92, v85 row_newbcast:4 row_mask:0xf bank_mask:0xf
    v_pk_fma_f32 v[52:53], v[108:109], v[92:93], v[52:53] op_sel_hi:[1,0,1]
    v_pk_fma_f32 v[54:55], v[110:111], v[92:93], v[54:55] op_sel_hi:[1,0,1]
    v_pk_fma_f32 v[56:57], v[112:113], v[92:93], v[56:57] op_sel_hi:[1,0,1]
    v_pk_fma_f32 v[58:59], v[114:115], v[92:93], v[58:59] op_sel_hi:[1,0,1]
    v_lshlrev_b32 v108, 16, v144
    v_and_b32 v109, s40, v144
    v_lshlrev_b32 v110, 16, v145
    v_and_b32 v111, s40, v145
    v_lshlrev_b32 v112, 16, v146
    v_and_b32 v113, s40, v146
    v_lshlrev_b32 v114, 16, v147
    v_and_b32 v115, s40, v147
    v_mov_b32_dpp v92, v85 row_newbcast:8 row_mask:0xf bank_mask:0xf
    v_pk_fma_f32 v[52:53], v[100:101], v[92:93], v[52:53] op_sel_hi:[1,0,1]
    v_pk_fma_f32 v[54:55], v[102:103], v[92:93], v[54:55] op_sel_hi:[1,0,1]
    v_pk_fma_f32 v[56:57], v[104:105], v[92:93], v[56:57] op_sel_hi:[1,0,1]
    v_pk_fma_f32 v[58:59], v[106:107], v[92:93], v[58:59] op_sel_hi:[1,0,1]
    v_mov_b32_dpp v92, v85 row_newbcast:12 row_mask:0xf bank_mask:0xf
    v_pk_fma_f32 v[52:53], v[108:109], v[92:93], v[52:53] op_sel_hi:[1,0,1]
    v_pk_fma_f32 v[54:55], v[110:111], v[92:93], v[54:55] op_sel_hi:[1,0,1]
    v_pk_fma_f32 v[56:57], v[112:113], v[92:93], v[56:57] op_sel_hi:[1,0,1]
    v_pk_fma_f32 v[58:59], v[114:115], v[92:93], v[58:59] op_sel_hi:[1,0,1]
    s_nop 0
    s_branch L_next
L_c4:
    v_cmp_gt_u32 s[52:53], s46, v6
    v_cmp_gt_u32 s[54:55], s47, v6
    v_cmp_gt_u32 s[56:57], s48, v6
    v_cmp_gt_u32 s[58:59], s49, v6
    v_dot2_f32_bf16 v68, v116, v12, 0
    v_dot2_f32_bf16 v69, v120, v12, 0
    v_dot2_f32_bf16 v70, v124, v12, 0
    v_dot2_f32_bf16 v71, v128, v12, 0
    v_dot2_f32_bf16 v72, v116, v16, 0
    v_dot2_f32_bf16 v73, v120, v16, 0
    v_dot2_f32_bf16 v74, v124, v16, 0
    v_dot2_f32_bf16 v75, v128, v16, 0
    v_dot2_f32_bf16 v76, v116, v20, 0
    v_dot2_f32_bf16 v77, v120, v20, 0
    v_dot2_f32_bf16 v78, v124, v20, 0
    v_dot2_f32_bf16 v79, v128, v20, 0
    v_dot2_f32_bf16 v80, v116, v24, 0
    v_dot2_f32_bf16 v81, v120, v24, 0
    v_dot2_f32_bf16 v82, v124, v24, 0
    v_dot2_f32_bf16 v83, v128, v24, 0
    v_dot2c_f32_bf16 v68, v117, v13
    v_dot2c_f32_bf16 v69, v121, v13
    v_dot2c_f32_bf16 v70, v125, v13
    v_dot2c_f32_bf16 v71, v129, v13
    v_dot2c_f32_bf16 v72, v117, v17
    v_dot2c_f32_bf16 v73, v121, v17
    v_dot2c_f32_bf16 v74, v125, v17
    v_dot2c_f32_bf16 v75, v129, v17
    v_dot2c_f32_bf16 v76, v117, v21
    v_dot2c_f32_bf16 v77, v121, v21
    v_dot2c_f32_bf16 v78, v125, v21
    v_dot2c_f32_bf16 v79, v129, v21
    v_dot2c_f32_bf16 v80, v117, v25
    v_dot2c_f32_bf16 v81, v121, v25
    v_dot2c_f32_bf16 v82, v125, v25
    v_dot2c_f32_bf16 v83, v129, v25
    v_dot2c_f32_bf16 v68, v118, v14
    v_dot2c_f32_bf16 v69, v122, v14
    v_dot2c_f32_bf16 v70, v126, v14
    v_dot2c_f32_bf16 v71, v130, v14
    v_dot2c_f32_bf16 v72, v118, v18
    v_dot2c_f32_bf16 v73, v122, v18
    v_dot2c_f32_bf16 v74, v126, v18
    v_dot2c_f32_bf16 v75, v130, v18
    v_dot2c_f32_bf16 v76, v118, v22
    v_dot2c_f32_bf16 v77, v122, v22
    v_dot2c_f32_bf16 v78, v126, v22
    v_dot2c_f32_bf16 v79, v130, v22
    v_dot2c_f32_bf16 v80, v118, v26
    v_dot2c_f32_bf16 v81, v122, v26
    v_dot2c_f32_bf16 v82, v126, v26
    v_dot2c_f32_bf16 v83, v130, v26
    v_dot2c_f32_bf16 v68, v119, v15
    v_dot2c_f32_bf16 v69, v123, v15
    v_dot2c_f32_bf16 v70, v127, v15
    v_dot2c_f32_bf16 v71, v131, v15
    v_dot2c_f32_bf16 v72, v119, v19
    v_dot2c_f32_bf16 v73, v123, v19
    v_dot2c_f32_bf16 v74, v127, v19
    v_dot2c_f32_bf16 v75, v131, v19
    v_dot2c_f32_bf16 v76, v119, v23
    v_dot2c_f32_bf16 v77, v123, v23
    v_dot2c_f32_bf16 v78, v127, v23
    v_dot2c_f32_bf16 v79, v131, v23
    v_dot2c_f32_bf16 v80, v119, v27
    v_dot2c_f32_bf16 v81, v123, v27
    v_dot2c_f32_bf16 v82, v127, v27
    v_dot2c_f32_bf16 v83, v131, v27
    v_lshlrev_b32 v100, 16, v132
    v_and_b32 v101, s40, v132
    v_lshlrev_b32 v102, 16, v133
    v_and_b32 v103, s40, v133
    v_lshlrev_b32 v104, 16, v134
    v_and_b32 v105, s40, v134
    v_lshlrev_b32 v106, 16, v135
    v_and_b32 v107, s40, v135
    v_add_f32_dpp v68, v68, v68 row_ror:8 row_mask:0xf bank_mask:0x3
    v_add_f32_dpp v69, v69, v69 row_ror:8 row_mask:0xf bank_mask:0x3
    s_nop 0
    v_add_f32_dpp v68, v70, v70 row_ror:8 row_mask:0xf bank_mask:0xc
    v_add_f32_dpp v69, v71, v71 row_ror:8 row_mask:0xf bank_mask:0xc
    v_add_f32_dpp v72, v72, v72 row_ror:8 row_mask:0xf bank_mask:0x3
    v_add_f32_dpp v73, v73, v73 row_ror:8 row_mask:0xf bank_mask:0x3
    s_nop 0
    v_add_f32_dpp v72, v74, v74 row_ror:8 row_mask:0xf bank_mask:0xc
    v_add_f32_dpp v73, v75, v75 row_ror:8 row_mask:0xf bank_mask:0xc
    v_add_f32_dpp v76, v76, v76 row_ror:8 row_mask:0xf bank_mask:0x3
    v_add_f32_dpp v77, v77, v77 row_ror:8 row_mask:0xf bank_mask:0x3
    s_nop 0
    v_add_f32_dpp v76, v78, v78 row_ror:8 row_mask:0xf bank_mask:0xc
    v_add_f32_dpp v77, v79, v79 row_ror:8 row_mask:0xf bank_mask:0xc
    v_add_f32_dpp v80, v80, v80 row_ror:8 row_mask:0xf bank_mask:0x3
    v_add_f32_dpp v81, v81, v81 row_ror:8 row_mask:0xf bank_mask:0x3
    s_nop 0
    v_add_f32_dpp v80, v82, v82 row_ror:8 row_mask:0xf bank_mask:0xc
    v_add_f32_dpp v81, v83, v83 row_ror:8 row_mask:0xf bank_mask:0xc
    v_lshlrev_b32 v108, 16, v136
    v_and_b32 v109, s40, v136
    v_lshlrev_b32 v110, 16, v137
    v_and_b32 v111, s40, v137
    v_lshlrev_b32 v112, 16, v138
    v_and_b32 v113, s40, v138
    v_lshlrev_b32 v114, 16, v139
    v_and_b32 v115, s40, v139
    v_add_f32_dpp v68, v68, v68 row_half_mirror row_mask:0xf bank_mask:0x5
    v_add_f32_dpp v72, v72, v72 row_half_mirror row_mask:0xf bank_mask:0x5
    v_add_f32_dpp v76, v76, v76 row_half_mirror row_mask:0xf bank_mask:0x5
    v_add_f32_dpp v80, v80, v80 row_half_mirror row_mask:0xf bank_mask:0x5
    v_add_f32_dpp v68, v69, v69 row_half_mirror row_mask:0xf bank_mask:0xa
    v_add_f32_dpp v72, v73, v73 row_half_mirror row_mask:0xf bank_mask:0xa
    v_add_f32_dpp v76, v77, v77 row_half_mirror row_mask:0xf bank_mask:0xa
    v_add_f32_dpp v80, v81, v81 row_half_mirror row_mask:0xf bank_mask:0xa
    v_add_f32_dpp v68, v68, v68 quad_perm:[1,0,3,2] row_mask:0xf bank_mask:0xf
    v_add_f32_dpp v72, v72, v72 quad_perm:[1,0,3,2] row_mask:0xf bank_mask:0xf
    v_add_f32_dpp v76, v76, v76 quad_perm:[1,0,3,2] row_mask:0xf bank_mask:0xf
    v_add_f32_dpp v80, v80, v80 quad_perm:[1,0,3,2] row_mask:0xf bank_mask:0xf
    v_add_f32_dpp v68, v68, v68 quad_perm:[2,3,0,1] row_mask:0xf bank_mask:0xf
    v_add_f32_dpp v72, v72, v72 quad_perm:[2,3,0,1] row_mask:0xf bank_mask:0xf
    v_add_f32_dpp v76, v76, v76 quad_perm:[2,3,0,1] row_mask:0xf bank_mask:0xf
    v_add_f32_dpp v80, v80, v80 quad_perm:[2,3,0,1] row_mask:0xf bank_mask:0xf
    v_mul_f32 v68, s39, v68
    v_mul_f32 v72, s39, v72
    v_mul_f32 v76, s39, v76
    v_mul_f32 v80, s39, v80
    v_cndmask_b32 v68, v7, v68, s[52:53]
    v_cndmask_b32 v72, v7, v72, s[54:55]
    v_cndmask_b32 v76, v7, v76, s[56:57]
    v_cndmask_b32 v80, v7, v80, s[58:59]
    v_max_f32 v93, v68, v60
    v_max_f32 v95, v72, v61
    v_max_f32 v97, v76, v62
    v_max_f32 v99, v80, v63
    v_max_f32_dpp v93, v93, v93 row_ror:4 row_mask:0xf bank_mask:0xf
    v_max_f32_dpp v95, v95, v95 row_ror:4 row_mask:0xf bank_mask:0xf
    v_max_f32_dpp v97, v97, v97 row_ror:4 row_mask:0xf bank_mask:0xf
    v_max_f32_dpp v99, v99, v99 row_ror:4 row_mask:0xf bank_mask:0xf
    v_max_f32_dpp v93, v93, v93 row_ror:8 row_mask:0xf bank_mask:0xf
    v_max_f32_dpp v95, v95, v95 row_ror:8 row_mask:0xf bank_mask:0xf
    v_max_f32_dpp v97, v97, v97 row_ror:8 row_mask:0xf bank_mask:0xf
    v_max_f32_dpp v99, v99, v99 row_ror:8 row_mask:0xf bank_mask:0xf
    v_sub_f32 v84, v60, v93
    v_sub_f32 v85, v68, v93
    v_sub_f32 v86, v61, v95
    v_sub_f32 v87, v72, v95
    v_sub_f32 v88, v62, v97
    v_sub_f32 v89, v76, v97
    v_sub_f32 v90, v63, v99
    v_sub_f32 v91, v80, v99
    v_exp_f32 v84, v84
    v_exp_f32 v85, v85
    v_exp_f32 v86, v86
    v_exp_f32 v87, v87
    v_exp_f32 v88, v88
    v_exp_f32 v89, v89
    v_exp_f32 v90, v90
    v_exp_f32 v91, v91
    v_mov_b32 v60, v93
    v_mov_b32 v61, v95
    v_mov_b32 v62, v97
    v_mov_b32 v63, v99
    v_fma_f32 v64, v64, v84, v85
    v_fma_f32 v65, v65, v86, v87
    v_fma_f32 v66, v66, v88, v89
    v_fma_f32 v67, v67, v90, v91
    v_pk_mul_f32 v[28:29], v[28:29], v[84:85] op_sel_hi:[1,0]
    v_pk_mul_f32 v[30:31], v[30:31], v[84:85] op_sel_hi:[1,0]
    v_pk_mul_f32 v[32:33], v[32:33], v[84:85] op_sel_hi:[1,0]
    v_pk_mul_f32 v[34:35], v[34:35], v[84:85] op_sel_hi:[1,0]
    v_pk_mul_f32 v[36:37], v[36:37], v[86:87] op_sel_hi:[1,0]
    v_pk_mul_f32 v[38:39], v[38:39], v[86:87] op_sel_hi:[1,0]
    v_pk_mul_f32 v[40:41], v[40:41], v[86:87] op_sel_hi:[1,0]
    v_pk_mul_f32 v[42:43], v[42:43], v[86:87] op_sel_hi:[1,0]
    v_pk_mul_f32 v[44:45], v[44:45], v[88:89] op_sel_hi:[1,0]
    v_pk_mul_f32 v[46:47], v[46:47], v[88:89] op_sel_hi:[1,0]
    v_pk_mul_f32 v[48:49], v[48:49], v[88:89] op_sel_hi:[1,0]
    v_pk_mul_f32 v[50:51], v[50:51], v[88:89] op_sel_hi:[1,0]
    v_pk_mul_f32 v[52:53], v[52:53], v[90:91] op_sel_hi:[1,0]
    v_pk_mul_f32 v[54:55], v[54:55], v[90:91] op_sel_hi:[1,0]
    v_pk_mul_f32 v[56:57], v[56:57], v[90:91] op_sel_hi:[1,0]
    v_pk_mul_f32 v[58:59], v[58:59], v[90:91] op_sel_hi:[1,0]
    v_mov_b32_dpp v92, v85 row_newbcast:0 row_mask:0xf bank_mask:0xf
    v_mov_b32_dpp v94, v87 row_newbcast:0 row_mask:0xf bank_mask:0xf
    v_mov_b32_dpp v96, v89 row_newbcast:0 row_mask:0xf bank_mask:0xf
    v_mov_b32_dpp v98, v91 row_newbcast:0 row_mask:0xf bank_mask:0xf
    v_pk_fma_f32 v[28:29], v[100:101], v[92:93], v[28:29] op_sel_hi:[1,0,1]
    v_pk_fma_f32 v[30:31], v[102:103], v[92:93], v[30:31] op_sel_hi:[1,0,1]
    v_pk_fma_f32 v[32:33], v[104:105], v[92:93], v[32:33] op_sel_hi:[1,0,1]
    v_pk_fma_f32 v[34:35], v[106:107], v[92:93], v[34:35] op_sel_hi:[1,0,1]
    v_pk_fma_f32 v[36:37], v[100:101], v[94:95], v[36:37] op_sel_hi:[1,0,1]
    v_pk_fma_f32 v[38:39], v[102:103], v[94:95], v[38:39] op_sel_hi:[1,0,1]
    v_pk_fma_f32 v[40:41], v[104:105], v[94:95], v[40:41] op_sel_hi:[1,0,1]
    v_pk_fma_f32 v[42:43], v[106:107], v[94:95], v[42:43] op_sel_hi:[1,0,1]
    v_pk_fma_f32 v[44:45], v[100:101], v[96:97], v[44:45] op_sel_hi:[1,0,1]
    v_pk_fma_f32 v[46:47], v[102:103], v[96:97], v[46:47] op_sel_hi:[1,0,1]
    v_pk_fma_f32 v[48:49], v[104:105], v[96:97], v[48:49] op_sel_hi:[1,0,1]
    v_pk_fma_f32 v[50:51], v[106:107], v[96:97], v[50:51] op_sel_hi:[1,0,1]
    v_pk_fma_f32 v[52:53], v[100:101], v[98:99], v[52:53] op_sel_hi:[1,0,1]
    v_pk_fma_f32 v[54:55], v[102:103], v[98:99], v[54:55] op_sel_hi:[1,0,1]
    v_pk_fma_f32 v[56:57], v[104:105], v[98:99], v[56:57] op_sel_hi:[1,0,1]
    v_pk_fma_f32 v[58:59], v[106:107], v[98:99], v[58:59] op_sel_hi:[1,0,1]
    v_lshlrev_b32 v100, 16, v140
    v_and_b32 v101, s40, v140
    v_lshlrev_b32 v102, 16, v141
    v_and_b32 v103, s40, v141
    v_lshlrev_b32 v104, 16, v142
    v_and_b32 v105, s40, v142
    v_lshlrev_b32 v106, 16, v143
    v_and_b32 v107, s40, v143
    v_mov_b32_dpp v92, v85 row_newbcast:4 row_mask:0xf bank_mask:0xf
    v_mov_b32_dpp v94, v87 row_newbcast:4 row_mask:0xf bank_mask:0xf
    v_mov_b32_dpp v96, v89 row_newbcast:4 row_mask:0xf bank_mask:0xf
    v_mov_b32_dpp v98, v91 row_newbcast:4 row_mask:0xf bank_mask:0xf
    v_pk_fma_f32 v[28:29], v[108:109], v[92:93], v[28:29] op_sel_hi:[1,0,1]
    v_pk_fma_f32 v[30:31], v[110:111], v[92:93], v[30:31] op_sel_hi:[1,0,1]
    v_pk_fma_f32 v[32:33], v[112:113], v[92:93], v[32:33] op_sel_hi:[1,0,1]
    v_pk_fma_f32 v[34:35], v[114:115], v[92:93], v[34:35] op_sel_hi:[1,0,1]
    v_pk_fma_f32 v[36:37], v[108:109], v[94:95], v[36:37] op_sel_hi:[1,0,1]
    v_pk_fma_f32 v[38:39], v[110:111], v[94:95], v[38:39] op_sel_hi:[1,0,1]
    v_pk_fma_f32 v[40:41], v[112:113], v[94:95], v[40:41] op_sel_hi:[1,0,1]
    v_pk_fma_f32 v[42:43], v[114:115], v[94:95], v[42:43] op_sel_hi:[1,0,1]
    v_pk_fma_f32 v[44:45], v[108:109], v[96:97], v[44:45] op_sel_hi:[1,0,1]
    v_pk_fma_f32 v[46:47], v[110:111], v[96:97], v[46:47] op_sel_hi:[1,0,1]
    v_pk_fma_f32 v[48:49], v[112:113], v[96:97], v[48:49] op_sel_hi:[1,0,1]
    v_pk_fma_f32 v[50:51], v[114:115], v[96:97], v[50:51] op_sel_hi:[1,0,1]
    v_pk_fma_f32 v[52:53], v[108:109], v[98:99], v[52:53] op_sel_hi:[1,0,1]
    v_pk_fma_f32 v[54:55], v[110:111], v[98:99], v[54:55] op_sel_hi:[1,0,1]
    v_pk_fma_f32 v[56:57], v[112:113], v[98:99], v[56:57] op_sel_hi:[1,0,1]
    v_pk_fma_f32 v[58:59], v[114:115], v[98:99], v[58:59] op_sel_hi:[1,0,1]
    v_lshlrev_b32 v108, 16, v144
    v_and_b32 v109, s40, v144
    v_lshlrev_b32 v110, 16, v145
    v_and_b32 v111, s40, v145
    v_lshlrev_b32 v112, 16, v146
    v_and_b32 v113, s40, v146
    v_lshlrev_b32 v114, 16, v147
    v_and_b32 v115, s40, v147
    v_mov_b32_dpp v92, v85 row_newbcast:8 row_mask:0xf bank_mask:0xf
    v_mov_b32_dpp v94, v87 row_newbcast:8 row_mask:0xf bank_mask:0xf
    v_mov_b32_dpp v96, v89 row_newbcast:8 row_mask:0xf bank_mask:0xf
    v_mov_b32_dpp v98, v91 row_newbcast:8 row_mask:0xf bank_mask:0xf
    v_pk_fma_f32 v[28:29], v[100:101], v[92:93], v[28:29] op_sel_hi:[1,0,1]
    v_pk_fma_f32 v[30:31], v[102:103], v[92:93], v[30:31] op_sel_hi:[1,0,1]
    v_pk_fma_f32 v[32:33], v[104:105], v[92:93], v[32:33] op_sel_hi:[1,0,1]
    v_pk_fma_f32 v[34:35], v[106:107], v[92:93], v[34:35] op_sel_hi:[1,0,1]
    v_pk_fma_f32 v[36:37], v[100:101], v[94:95], v[36:37] op_sel_hi:[1,0,1]
    v_pk_fma_f32 v[38:39], v[102:103], v[94:95], v[38:39] op_sel_hi:[1,0,1]
    v_pk_fma_f32 v[40:41], v[104:105], v[94:95], v[40:41] op_sel_hi:[1,0,1]
    v_pk_fma_f32 v[42:43], v[106:107], v[94:95], v[42:43] op_sel_hi:[1,0,1]
    v_pk_fma_f32 v[44:45], v[100:101], v[96:97], v[44:45] op_sel_hi:[1,0,1]
    v_pk_fma_f32 v[46:47], v[102:103], v[96:97], v[46:47] op_sel_hi:[1,0,1]
    v_pk_fma_f32 v[48:49], v[104:105], v[96:97], v[48:49] op_sel_hi:[1,0,1]
    v_pk_fma_f32 v[50:51], v[106:107], v[96:97], v[50:51] op_sel_hi:[1,0,1]
    v_pk_fma_f32 v[52:53], v[100:101], v[98:99], v[52:53] op_sel_hi:[1,0,1]
    v_pk_fma_f32 v[54:55], v[102:103], v[98:99], v[54:55] op_sel_hi:[1,0,1]
    v_pk_fma_f32 v[56:57], v[104:105], v[98:99], v[56:57] op_sel_hi:[1,0,1]
    v_pk_fma_f32 v[58:59], v[106:107], v[98:99], v[58:59] op_sel_hi:[1,0,1]
    v_mov_b32_dpp v92, v85 row_newbcast:12 row_mask:0xf bank_mask:0xf
    v_mov_b32_dpp v94, v87 row_newbcast:12 row_mask:0xf bank_mask:0xf
    v_mov_b32_dpp v96, v89 row_newbcast:12 row_mask:0xf bank_mask:0xf
    v_mov_b32_dpp v98, v91 row_newbcast:12 row_mask:0xf bank_mask:0xf
    v_pk_fma_f32 v[28:29], v[108:109], v[92:93], v[28:29] op_sel_hi:[1,0,1]
    v_pk_fma_f32 v[30:31], v[110:111], v[92:93], v[30:31] op_sel_hi:[1,0,1]
    v_pk_fma_f32 v[32:33], v[112:113], v[92:93], v[32:33] op_sel_hi:[1,0,1]
    v_pk_fma_f32 v[34:35], v[114:115], v[92:93], v[34:35] op_sel_hi:[1,0,1]
    v_pk_fma_f32 v[36:37], v[108:109], v[94:95], v[36:37] op_sel_hi:[1,0,1]
    v_pk_fma_f32 v[38:39], v[110:111], v[94:95], v[38:39] op_sel_hi:[1,0,1]
    v_pk_fma_f32 v[40:41], v[112:113], v[94:95], v[40:41] op_sel_hi:[1,0,1]
    v_pk_fma_f32 v[42:43], v[114:115], v[94:95], v[42:43] op_sel_hi:[1,0,1]
    v_pk_fma_f32 v[44:45], v[108:109], v[96:97], v[44:45] op_sel_hi:[1,0,1]
    v_pk_fma_f32 v[46:47], v[110:111], v[96:97], v[46:47] op_sel_hi:[1,0,1]
    v_pk_fma_f32 v[48:49], v[112:113], v[96:97], v[48:49] op_sel_hi:[1,0,1]
    v_pk_fma_f32 v[50:51], v[114:115], v[96:97], v[50:51] op_sel_hi:[1,0,1]
    v_pk_fma_f32 v[52:53], v[108:109], v[98:99], v[52:53] op_sel_hi:[1,0,1]
    v_pk_fma_f32 v[54:55], v[110:111], v[98:99], v[54:55] op_sel_hi:[1,0,1]
    v_pk_fma_f32 v[56:57], v[112:113], v[98:99], v[56:57] op_sel_hi:[1,0,1]
    v_pk_fma_f32 v[58:59], v[114:115], v[98:99], v[58:59] op_sel_hi:[1,0,1]
L_next:
    s_add_u32 s41, s41, 1
    s_branch L_loop
L_done:
    s_cmp_lg_u32 s67, 0
    s_cbranch_scc0 L_elect
    s_mov_b64 exec, 1
    global_atomic_add v215, v8, v9, s[22:23] offset:1024 sc0
    s_mov_b64 exec, -1
    v_add_f32_dpp v64, v64, v64 row_ror:4 row_mask:0xf bank_mask:0xf
    v_add_f32_dpp v65, v65, v65 row_ror:4 row_mask:0xf bank_mask:0xf
    v_add_f32_dpp v66, v66, v66 row_ror:4 row_mask:0xf bank_mask:0xf
    v_add_f32_dpp v67, v67, v67 row_ror:4 row_mask:0xf bank_mask:0xf
    v_lshlrev_b32 v116, 4, v1
    s_lshl_b32 s3, s36, 13
    v_add_u32 v10, s3, v116
    v_add_f32_dpp v69, v64, v64 row_ror:8 row_mask:0xf bank_mask:0xf
    v_add_f32_dpp v73, v65, v65 row_ror:8 row_mask:0xf bank_mask:0xf
    v_add_f32_dpp v77, v66, v66 row_ror:8 row_mask:0xf bank_mask:0xf
    v_add_f32_dpp v81, v67, v67 row_ror:8 row_mask:0xf bank_mask:0xf
    ds_write_b128 v10, v[28:31] offset:17152
    ds_write_b128 v10, v[32:35] offset:18176
    ds_write_b128 v10, v[36:39] offset:19200
    ds_write_b128 v10, v[40:43] offset:20224
    ds_write_b128 v10, v[44:47] offset:21248
    ds_write_b128 v10, v[48:51] offset:22272
    ds_write_b128 v10, v[52:55] offset:23296
    ds_write_b128 v10, v[56:59] offset:24320
    v_mov_b32 v68, v60
    v_mov_b32 v72, v61
    v_mov_b32 v76, v62
    v_mov_b32 v80, v63
    v_lshrrev_b32 v117, 4, v1
    v_lshlrev_b32 v117, 3, v117
    s_lshl_b32 s3, s36, 7
    v_add_u32 v11, s3, v117
    s_mov_b32 exec_lo, 0x00010001
    s_mov_b32 exec_hi, 0x00010001
    ds_write_b64 v11, v[68:69] offset:16640
    ds_write_b64 v11, v[72:73] offset:16672
    ds_write_b64 v11, v[76:77] offset:16704
    ds_write_b64 v11, v[80:81] offset:16736
    s_mov_b64 exec, -1
    s_waitcnt lgkmcnt(0)
    s_barrier
    s_lshl_b32 s3, s36, 11
    v_add_u32 v10, s3, v116
    s_lshl_b32 s3, s36, 5
    v_add_u32 v11, s3, v117
    ds_read_b64 v[118:119], v11 offset:16640
    ds_read_b64 v[120:121], v11 offset:16768
    ds_read_b64 v[122:123], v11 offset:16896
    ds_read_b64 v[124:125], v11 offset:17024
    ds_read_b128 v[28:31], v10 offset:17152
    ds_read_b128 v[32:35], v10 offset:18176
    ds_read_b128 v[36:39], v10 offset:25344
    ds_read_b128 v[40:43], v10 offset:26368
    ds_read_b128 v[44:47], v10 offset:33536
    ds_read_b128 v[48:51], v10 offset:34560
    ds_read_b128 v[52:55], v10 offset:41728
    ds_read_b128 v[56:59], v10 offset:42752
    s_lshl_b32 s3, s37, 2
    s_add_u32 s3, s3, s36
    s_mul_i32 s3, s3, 66560
    s_add_u32 s60, s22, s3
    s_addc_u32 s61, s23, 0
    s_and_b32 s61, s61, 0xffff
    s_mov_b32 s62, 66560
    s_mov_b32 s63, 0x00020000
    s_lshl_b32 s45, s38, 11
    v_lshlrev_b32 v84, 5, v117
    s_lshl_b32 s3, s38, 3
    v_add_u32 v84, s3, v84
    s_mov_b32 s4, 65536
    s_waitcnt lgkmcnt(8)
    v_max3_f32 v68, v118, v120, v122
    v_max_f32 v68, v68, v124
    v_sub_f32 v118, v118, v68
    v_sub_f32 v120, v120, v68
    v_sub_f32 v122, v122, v68
    v_sub_f32 v124, v124, v68
    v_exp_f32 v118, v118
    v_exp_f32 v120, v120
    v_exp_f32 v122, v122
    v_exp_f32 v124, v124
    v_mul_f32 v69, v119, v118
    v_fmac_f32 v69, v121, v120
    v_fmac_f32 v69, v123, v122
    v_fmac_f32 v69, v125, v124
    v_min_u32 v68, -2, v68
    v_min_u32 v69, -2, v69
    s_mov_b32 exec_lo, 0x00010001
    s_mov_b32 exec_hi, 0x00010001
    buffer_store_dwordx2 v[68:69], v84, s[60:63], s4 offen sc1
    s_mov_b64 exec, -1
    s_waitcnt lgkmcnt(0)
    v_mul_f32 v72, v28, v118
    v_mul_f32 v73, v29, v118
    v_mul_f32 v74, v30, v118
    v_mul_f32 v75, v31, v118
    v_mul_f32 v76, v32, v118
    v_mul_f32 v77, v33, v118
    v_mul_f32 v78, v34, v118
    v_mul_f32 v79, v35, v118
    v_fmac_f32 v72, v36, v120
    v_fmac_f32 v73, v37, v120
    v_fmac_f32 v74, v38, v120
    v_fmac_f32 v75, v39, v120
    v_fmac_f32 v76, v40, v120
    v_fmac_f32 v77, v41, v120
    v_fmac_f32 v78, v42, v120
    v_fmac_f32 v79, v43, v120
    v_fmac_f32 v72, v44, v122
    v_fmac_f32 v73, v45, v122
    v_fmac_f32 v74, v46, v122
    v_fmac_f32 v75, v47, v122
    v_fmac_f32 v76, v48, v122
    v_fmac_f32 v77, v49, v122
    v_fmac_f32 v78, v50, v122
    v_fmac_f32 v79, v51, v122
    v_fmac_f32 v72, v52, v124
    v_fmac_f32 v73, v53, v124
    v_fmac_f32 v74, v54, v124
    v_fmac_f32 v75, v55, v124
    v_fmac_f32 v76, v56, v124
    v_fmac_f32 v77, v57, v124
    v_fmac_f32 v78, v58, v124
    v_fmac_f32 v79, v59, v124
    v_min_u32 v72, -2, v72
    v_min_u32 v73, -2, v73
    v_min_u32 v74, -2, v74
    v_min_u32 v75, -2, v75
    v_min_u32 v76, -2, v76
    v_min_u32 v77, -2, v77
    v_min_u32 v78, -2, v78
    v_min_u32 v79, -2, v79
    buffer_store_dwordx4 v[72:75], v116, s[60:63], s45 offen sc1
    buffer_store_dwordx4 v[76:79], v116, s[60:63], s45 offen offset:1024 sc1
    v_lshrrev_b32 v84, 4, v1
    v_lshlrev_b32 v84, 10, v84
    v_and_b32 v85, 15, v1
    v_lshl_add_u32 v84, v85, 4, v84
    v_lshrrev_b32 v86, 5, v1
    v_lshl_add_u32 v85, v85, 1, v86
    v_lshlrev_b32 v85, 3, v85
    s_waitcnt vmcnt(3)
    v_readfirstlane_b32 s3, v215
    s_nop 0
    s_cmp_lt_u32 s3, 28
    s_nop 1
    s_cbranch_scc1 L_exit
    s_sub_u32 s52, s3, 28
    s_mov_b32 s53, 0
    s_cmp_eq_u32 s3, 31
    s_cbranch_scc1 L_comb
L_spinC:
    global_load_dword v217, v8, s[22:23] offset:1024 sc1
    s_waitcnt vmcnt(0)
    v_readfirstlane_b32 s3, v217
    s_nop 0
    s_cmp_lt_u32 s3, 32
    s_nop 1
    s_cbranch_scc1 L_spinC
L_comb:
    s_lshl_b32 s4, s52, 8
    s_add_u32 s5, s4, 65536
    buffer_load_dwordx2 v[68:69], v85, s[60:63], s5 offen sc1
    buffer_load_dwordx4 v[116:119], v84, s[60:63], s4 offen sc1
    s_add_u32 s4, s4, 4096
    buffer_load_dwordx4 v[120:123], v84, s[60:63], s4 offen sc1
    s_add_u32 s4, s4, 4096
    buffer_load_dwordx4 v[124:127], v84, s[60:63], s4 offen sc1
    s_add_u32 s4, s4, 4096
    buffer_load_dwordx4 v[128:131], v84, s[60:63], s4 offen sc1
    s_add_u32 s4, s4, 4096
    buffer_load_dwordx4 v[132:135], v84, s[60:63], s4 offen sc1
    s_add_u32 s4, s4, 4096
    buffer_load_dwordx4 v[136:139], v84, s[60:63], s4 offen sc1
    s_add_u32 s4, s4, 4096
    buffer_load_dwordx4 v[140:143], v84, s[60:63], s4 offen sc1
    s_add_u32 s4, s4, 4096
    buffer_load_dwordx4 v[144:147], v84, s[60:63], s4 offen sc1
    s_add_u32 s4, s4, 4096
    buffer_load_dwordx4 v[148:151], v84, s[60:63], s4 offen sc1
    s_add_u32 s4, s4, 4096
    buffer_load_dwordx4 v[152:155], v84, s[60:63], s4 offen sc1
    s_add_u32 s4, s4, 4096
    buffer_load_dwordx4 v[156:159], v84, s[60:63], s4 offen sc1
    s_add_u32 s4, s4, 4096
    buffer_load_dwordx4 v[160:163], v84, s[60:63], s4 offen sc1
    s_add_u32 s4, s4, 4096
    buffer_load_dwordx4 v[28:31], v84, s[60:63], s4 offen sc1
    s_add_u32 s4, s4, 4096
    buffer_load_dwordx4 v[32:35], v84, s[60:63], s4 offen sc1
    s_add_u32 s4, s4, 4096
    buffer_load_dwordx4 v[36:39], v84, s[60:63], s4 offen sc1
    s_add_u32 s4, s4, 4096
    buffer_load_dwordx4 v[40:43], v84, s[60:63], s4 offen sc1
    s_lshl_b32 s3, s37, 2
    s_add_u32 s3, s3, s52
    s_lshl_b32 s3, s3, 8
    s_lshl_b32 s4, s36, 13
    s_add_u32 s3, s3, s4
    v_and_b32 v87, 15, v1
    v_lshlrev_b32 v87, 4, v87
    v_bfe_u32 v88, v1, 4, 1
    v_lshl_add_u32 v87, v88, 3, v87
    v_add_u32 v87, s3, v87
    s_waitcnt vmcnt(16)
    v_max_u32 v74, v68, v69
    v_max_f32_dpp v70, v68, v68 row_ror:1 row_mask:0xf bank_mask:0xf
    s_nop 1
    v_max_f32_dpp v70, v70, v70 row_ror:2 row_mask:0xf bank_mask:0xf
    s_nop 1
    v_max_f32_dpp v70, v70, v70 row_ror:4 row_mask:0xf bank_mask:0xf
    s_nop 1
    v_max_f32_dpp v70, v70, v70 row_ror:8 row_mask:0xf bank_mask:0xf
    v_mov_b32 v73, v70
    s_nop 1
    v_permlane32_swap_b32 v70, v73
    v_max_f32 v70, v70, v73
    v_sub_f32 v71, v68, v70
    v_exp_f32 v71, v71
    s_nop 0
    v_mul_f32 v72, v69, v71
    s_nop 1
    v_add_f32_dpp v72, v72, v72 row_ror:1 row_mask:0xf bank_mask:0xf
    s_nop 1
    v_add_f32_dpp v72, v72, v72 row_ror:2 row_mask:0xf bank_mask:0xf
    s_nop 1
    v_add_f32_dpp v72, v72, v72 row_ror:4 row_mask:0xf bank_mask:0xf
    s_nop 1
    v_add_f32_dpp v72, v72, v72 row_ror:8 row_mask:0xf bank_mask:0xf
    v_mov_b32 v73, v72
    s_nop 1
    v_permlane32_swap_b32 v72, v73
    v_add_f32 v72, v72, v73
    v_rcp_f32 v72, v72
    v_mov_b32_dpp v92, v71 row_newbcast:0 row_mask:0xf bank_mask:0xf
    s_waitcnt vmcnt(15)
    v_max3_u32 v74, v74, v116, v117
    v_max3_u32 v74, v74, v118, v119
    v_pk_mul_f32 v[76:77], v[116:117], v[92:93] op_sel_hi:[1,0]
    v_pk_mul_f32 v[78:79], v[118:119], v[92:93] op_sel_hi:[1,0]
    v_mov_b32_dpp v94, v71 row_newbcast:1 row_mask:0xf bank_mask:0xf
    s_waitcnt vmcnt(14)
    v_max3_u32 v74, v74, v120, v121
    v_max3_u32 v74, v74, v122, v123
    v_pk_fma_f32 v[76:77], v[120:121], v[94:95], v[76:77] op_sel_hi:[1,0,1]
    v_pk_fma_f32 v[78:79], v[122:123], v[94:95], v[78:79] op_sel_hi:[1,0,1]
    v_mov_b32_dpp v92, v71 row_newbcast:2 row_mask:0xf bank_mask:0xf
    s_waitcnt vmcnt(13)
    v_max3_u32 v74, v74, v124, v125
    v_max3_u32 v74, v74, v126, v127
    v_pk_fma_f32 v[76:77], v[124:125], v[92:93], v[76:77] op_sel_hi:[1,0,1]
    v_pk_fma_f32 v[78:79], v[126:127], v[92:93], v[78:79] op_sel_hi:[1,0,1]
    v_mov_b32_dpp v94, v71 row_newbcast:3 row_mask:0xf bank_mask:0xf
    s_waitcnt vmcnt(12)
    v_max3_u32 v74, v74, v128, v129
    v_max3_u32 v74, v74, v130, v131
    v_pk_fma_f32 v[76:77], v[128:129], v[94:95], v[76:77] op_sel_hi:[1,0,1]
    v_pk_fma_f32 v[78:79], v[130:131], v[94:95], v[78:79] op_sel_hi:[1,0,1]
    v_mov_b32_dpp v92, v71 row_newbcast:4 row_mask:0xf bank_mask:0xf
    s_waitcnt vmcnt(11)
    v_max3_u32 v74, v74, v132, v133
    v_max3_u32 v74, v74, v134, v135
    v_pk_fma_f32 v[76:77], v[132:133], v[92:93], v[76:77] op_sel_hi:[1,0,1]
    v_pk_fma_f32 v[78:79], v[134:135], v[92:93], v[78:79] op_sel_hi:[1,0,1]
    v_mov_b32_dpp v94, v71 row_newbcast:5 row_mask:0xf bank_mask:0xf
    s_waitcnt vmcnt(10)
    v_max3_u32 v74, v74, v136, v137
    v_max3_u32 v74, v74, v138, v139
    v_pk_fma_f32 v[76:77], v[136:137], v[94:95], v[76:77] op_sel_hi:[1,0,1]
    v_pk_fma_f32 v[78:79], v[138:139], v[94:95], v[78:79] op_sel_hi:[1,0,1]
    v_mov_b32_dpp v92, v71 row_newbcast:6 row_mask:0xf bank_mask:0xf
    s_waitcnt vmcnt(9)
    v_max3_u32 v74, v74, v140, v141
    v_max3_u32 v74, v74, v142, v143
    v_pk_fma_f32 v[76:77], v[140:141], v[92:93], v[76:77] op_sel_hi:[1,0,1]
    v_pk_fma_f32 v[78:79], v[142:143], v[92:93], v[78:79] op_sel_hi:[1,0,1]
    v_mov_b32_dpp v94, v71 row_newbcast:7 row_mask:0xf bank_mask:0xf
    s_waitcnt vmcnt(8)
    v_max3_u32 v74, v74, v144, v145
    v_max3_u32 v74, v74, v146, v147
    v_pk_fma_f32 v[76:77], v[144:145], v[94:95], v[76:77] op_sel_hi:[1,0,1]
    v_pk_fma_f32 v[78:79], v[146:147], v[94:95], v[78:79] op_sel_hi:[1,0,1]
    v_mov_b32_dpp v92, v71 row_newbcast:8 row_mask:0xf bank_mask:0xf
    s_waitcnt vmcnt(7)
    v_max3_u32 v74, v74, v148, v149
    v_max3_u32 v74, v74, v150, v151
    v_pk_fma_f32 v[76:77], v[148:149], v[92:93], v[76:77] op_sel_hi:[1,0,1]
    v_pk_fma_f32 v[78:79], v[150:151], v[92:93], v[78:79] op_sel_hi:[1,0,1]
    v_mov_b32_dpp v94, v71 row_newbcast:9 row_mask:0xf bank_mask:0xf
    s_waitcnt vmcnt(6)
    v_max3_u32 v74, v74, v152, v153
    v_max3_u32 v74, v74, v154, v155
    v_pk_fma_f32 v[76:77], v[152:153], v[94:95], v[76:77] op_sel_hi:[1,0,1]
    v_pk_fma_f32 v[78:79], v[154:155], v[94:95], v[78:79] op_sel_hi:[1,0,1]
    v_mov_b32_dpp v92, v71 row_newbcast:10 row_mask:0xf bank_mask:0xf
    s_waitcnt vmcnt(5)
    v_max3_u32 v74, v74, v156, v157
    v_max3_u32 v74, v74, v158, v159
    v_pk_fma_f32 v[76:77], v[156:157], v[92:93], v[76:77] op_sel_hi:[1,0,1]
    v_pk_fma_f32 v[78:79], v[158:159], v[92:93], v[78:79] op_sel_hi:[1,0,1]
    v_mov_b32_dpp v94, v71 row_newbcast:11 row_mask:0xf bank_mask:0xf
    s_waitcnt vmcnt(4)
    v_max3_u32 v74, v74, v160, v161
    v_max3_u32 v74, v74, v162, v163
    v_pk_fma_f32 v[76:77], v[160:161], v[94:95], v[76:77] op_sel_hi:[1,0,1]
    v_pk_fma_f32 v[78:79], v[162:163], v[94:95], v[78:79] op_sel_hi:[1,0,1]
    v_mov_b32_dpp v92, v71 row_newbcast:12 row_mask:0xf bank_mask:0xf
    s_waitcnt vmcnt(3)
    v_max3_u32 v74, v74, v28, v29
    v_max3_u32 v74, v74, v30, v31
    v_pk_fma_f32 v[76:77], v[28:29], v[92:93], v[76:77] op_sel_hi:[1,0,1]
    v_pk_fma_f32 v[78:79], v[30:31], v[92:93], v[78:79] op_sel_hi:[1,0,1]
    v_mov_b32_dpp v94, v71 row_newbcast:13 row_mask:0xf bank_mask:0xf
    s_waitcnt vmcnt(2)
    v_max3_u32 v74, v74, v32, v33
    v_max3_u32 v74, v74, v34, v35
    v_pk_fma_f32 v[76:77], v[32:33], v[94:95], v[76:77] op_sel_hi:[1,0,1]
    v_pk_fma_f32 v[78:79], v[34:35], v[94:95], v[78:79] op_sel_hi:[1,0,1]
    v_mov_b32_dpp v92, v71 row_newbcast:14 row_mask:0xf bank_mask:0xf
    s_waitcnt vmcnt(1)
    v_max3_u32 v74, v74, v36, v37
    v_max3_u32 v74, v74, v38, v39
    v_pk_fma_f32 v[76:77], v[36:37], v[92:93], v[76:77] op_sel_hi:[1,0,1]
    v_pk_fma_f32 v[78:79], v[38:39], v[92:93], v[78:79] op_sel_hi:[1,0,1]
    v_mov_b32_dpp v94, v71 row_newbcast:15 row_mask:0xf bank_mask:0xf
    s_waitcnt vmcnt(0)
    v_max3_u32 v74, v74, v40, v41
    v_max3_u32 v74, v74, v42, v43
    v_pk_fma_f32 v[76:77], v[40:41], v[94:95], v[76:77] op_sel_hi:[1,0,1]
    v_pk_fma_f32 v[78:79], v[42:43], v[94:95], v[78:79] op_sel_hi:[1,0,1]
    v_cmp_eq_u32 vcc, -1, v74
    s_add_u32 s53, s53, 1
    s_cmp_gt_u32 s53, 0x100000
    s_nop 1
    s_cbranch_scc1 L_combfin
    s_cbranch_vccnz L_comb
L_combfin:
    v_mov_b32 v80, v76
    v_mov_b32 v81, v77
    v_mov_b32 v82, v78
    v_mov_b32 v83, v79
    v_permlane32_swap_b32 v76, v80
    v_permlane32_swap_b32 v77, v81
    v_permlane32_swap_b32 v78, v82
    v_permlane32_swap_b32 v79, v83
    v_add_f32 v76, v76, v80
    v_add_f32 v77, v77, v81
    v_add_f32 v78, v78, v82
    v_add_f32 v79, v79, v83
    v_mul_f32 v76, v76, v72
    v_mul_f32 v77, v77, v72
    v_mul_f32 v78, v78, v72
    v_mul_f32 v79, v79, v72
    v_cvt_pk_bf16_f32 v76, v76, v77
    v_cvt_pk_bf16_f32 v77, v78, v79
    s_mov_b32 exec_lo, -1
    s_mov_b32 exec_hi, 0
    global_store_dwordx2 v87, v[76:77], s[18:19]
    s_mov_b64 exec, -1
L_exit:
L_exit2:
    s_endpgm
L_slowstart:
    s_waitcnt lgkmcnt(0)
L_gc_spinS:
    ds_read_b32 v100, v216 offset:0
    s_waitcnt lgkmcnt(0)
    v_readfirstlane_b32 s42, v100
    s_nop 0
    s_cmp_eq_u32 s42, 0
    s_nop 1
    s_cbranch_scc1 L_gc_spinS
    s_sub_u32 s42, s42, 1
    s_mul_i32 s51, s42, 6
    s_lshr_b32 s51, s51, 8
    s_max_u32 s51, s51, 4
    s_lshl_b32 s65, s51, 5
    s_sub_u32 s64, s51, 3
    s_sub_u32 s71, s64, 1
    v_lshlrev_b32 v10, 5, v1
    v_add_u32 v10, s38, v10
    v_lshlrev_b32 v10, 3, v10
    ds_read_b64 v[80:81], v10 offset:256
    s_waitcnt vmcnt(0) lgkmcnt(0)
    v_readlane_b32 s45, v80, 0
    v_readlane_b32 s60, v81, 0
    s_add_u32 s3, s38, 0
    s_cmp_lt_u32 s3, s42
    s_cselect_b32 s26, 0xa000000, 0
    s_cselect_b32 s60, s60, 0
    s_cselect_b32 s45, s45, 0
    s_mov_b32 s30, s26
    global_load_dword v212, v216, s[14:15]
    buffer_load_dwordx4 v[148:151], v2, s[24:27], s45 offen nt
    buffer_load_dwordx4 v[152:155], v3, s[24:27], s45 offen nt
    buffer_load_dwordx4 v[156:159], v4, s[24:27], s45 offen nt
    buffer_load_dwordx4 v[160:163], v5, s[24:27], s45 offen nt
    buffer_load_dwordx4 v[164:167], v2, s[28:31], s45 offen nt
    buffer_load_dwordx4 v[168:171], v3, s[28:31], s45 offen nt
    buffer_load_dwordx4 v[172:175], v4, s[28:31], s45 offen nt
    buffer_load_dwordx4 v[176:179], v5, s[28:31], s45 offen nt
    v_readlane_b32 s45, v80, 1
    v_readlane_b32 s61, v81, 1
    s_add_u32 s3, s38, 32
    s_cmp_lt_u32 s3, s42
    s_cselect_b32 s26, 0xa000000, 0
    s_cselect_b32 s61, s61, 0
    s_cselect_b32 s45, s45, 0
    s_mov_b32 s30, s26
    global_load_dword v213, v216, s[14:15]
    buffer_load_dwordx4 v[180:183], v2, s[24:27], s45 offen nt
    buffer_load_dwordx4 v[184:187], v3, s[24:27], s45 offen nt
    buffer_load_dwordx4 v[188:191], v4, s[24:27], s45 offen nt
    buffer_load_dwordx4 v[192:195], v5, s[24:27], s45 offen nt
    buffer_load_dwordx4 v[196:199], v2, s[28:31], s45 offen nt
    buffer_load_dwordx4 v[200:203], v3, s[28:31], s45 offen nt
    buffer_load_dwordx4 v[204:207], v4, s[28:31], s45 offen nt
    buffer_load_dwordx4 v[208:211], v5, s[28:31], s45 offen nt
    s_branch L_loop
L_getconst:
    s_waitcnt lgkmcnt(0)
L_gc_spinF:
    ds_read_b32 v100, v216 offset:0
    s_waitcnt lgkmcnt(0)
    v_readfirstlane_b32 s42, v100
    s_nop 0
    s_cmp_eq_u32 s42, 0
    s_nop 1
    s_cbranch_scc1 L_gc_spinF
    s_sub_u32 s42, s42, 1
    s_mul_i32 s51, s42, 6
    s_lshr_b32 s51, s51, 8
    s_max_u32 s51, s51, 10
    s_lshl_b32 s65, s51, 5
    s_sub_u32 s64, s51, 3
    s_sub_u32 s71, s64, 1
    s_branch L_loop
L_elect:
    s_waitcnt lgkmcnt(0)
    s_mov_b32 s5, 0
L_el_poll:
    s_mov_b64 exec, 1
    global_load_dword v100, v214, s[20:21] sc1
    s_mov_b64 exec, -1
    s_waitcnt vmcnt(0)
    v_readfirstlane_b32 s4, v100
    s_nop 0
    s_lshr_b32 s4, s4, 16
    s_cmp_lg_u32 s4, 0
    s_nop 0
    s_cbranch_scc1 L_el_ret
    s_add_u32 s5, s5, 1
    s_cmp_lg_u32 s5, 12
    s_cbranch_scc1 L_el_poll
    s_mov_b64 exec, 1
    global_atomic_add v100, v214, v9, s[20:21] sc0
    s_mov_b64 exec, -1
    s_waitcnt vmcnt(0)
    v_readfirstlane_b32 s4, v100
    s_nop 0
    s_and_b32 s4, s4, 0xffff
    s_cmp_lg_u32 s4, 0
    s_nop 0
    s_cbranch_scc1 L_el_poll
    s_lshl_b32 s4, s36, 8
    v_lshlrev_b32 v101, 8, v1
    v_add_u32 v101, v101, v8
    v_subrev_u32 v101, s4, v101
    v_mov_b32 v102, 0
    s_mov_b64 exec, 0xff
    global_atomic_swap v100, v101, v102, s[22:23] sc0
    s_waitcnt vmcnt(0)
    v_mov_b32 v102, 0x10000
    s_mov_b64 exec, 1
    global_atomic_add v214, v102, s[20:21]
    s_mov_b64 exec, -1
    s_waitcnt vmcnt(0)
L_el_ret:
    s_mov_b32 s67, 1
    s_branch L_loop
L_builder:
    s_load_dwordx4 s[32:35], s[16:17], 0
    v_lshlrev_b32 v96, 2, v1
    v_add_u32 v97, 2048, v96
    v_add_u32 v98, 4096, v96
    v_add_u32 v99, 6144, v96
    global_load_dword v32, v96, s[14:15] offset:0
    global_load_dword v34, v97, s[14:15] offset:0
    global_load_dword v36, v98, s[14:15] offset:0
    global_load_dword v38, v99, s[14:15] offset:0
    global_load_dword v40, v96, s[14:15] offset:256
    global_load_dword v42, v97, s[14:15] offset:256
    global_load_dword v44, v98, s[14:15] offset:256
    global_load_dword v46, v99, s[14:15] offset:256
    global_load_dword v48, v96, s[14:15] offset:512
    global_load_dword v50, v97, s[14:15] offset:512
    global_load_dword v52, v98, s[14:15] offset:512
    global_load_dword v54, v99, s[14:15] offset:512
    global_load_dword v56, v96, s[14:15] offset:768
    global_load_dword v58, v97, s[14:15] offset:768
    global_load_dword v60, v98, s[14:15] offset:768
    global_load_dword v62, v99, s[14:15] offset:768
    global_load_dword v64, v96, s[14:15] offset:1024
    global_load_dword v66, v97, s[14:15] offset:1024
    global_load_dword v68, v98, s[14:15] offset:1024
    global_load_dword v70, v99, s[14:15] offset:1024
    global_load_dword v72, v96, s[14:15] offset:1280
    global_load_dword v74, v97, s[14:15] offset:1280
    global_load_dword v76, v98, s[14:15] offset:1280
    global_load_dword v78, v99, s[14:15] offset:1280
    global_load_dword v80, v96, s[14:15] offset:1536
    global_load_dword v82, v97, s[14:15] offset:1536
    global_load_dword v84, v98, s[14:15] offset:1536
    global_load_dword v86, v99, s[14:15] offset:1536
    global_load_dword v88, v96, s[14:15] offset:1792
    global_load_dword v90, v97, s[14:15] offset:1792
    global_load_dword v92, v98, s[14:15] offset:1792
    global_load_dword v94, v99, s[14:15] offset:1792
    s_lshl_b32 s3, s37, 2
    s_mul_i32 s3, s3, 66560
    s_lshl_b32 s4, s38, 11
    s_add_u32 s4, s4, s3
    v_lshlrev_b32 v104, 4, v1
    v_add_u32 v105, s4, v104
    v_lshrrev_b32 v106, 2, v1
    v_mul_u32_u24 v106, 66560, v106
    v_and_b32 v113, 3, v1
    v_lshl_add_u32 v106, v113, 8, v106
    s_lshl_b32 s4, s38, 3
    s_add_u32 s4, s4, s3
    s_add_u32 s4, s4, 65536
    v_add_u32 v106, s4, v106
    v_mov_b32 v108, -1
    v_mov_b32 v109, -1
    v_mov_b32 v110, -1
    v_mov_b32 v111, -1
    global_store_dwordx4 v105, v[108:111], s[22:23] sc1
    global_store_dwordx4 v105, v[108:111], s[22:23] offset:1024 sc1
    v_add_u32 v105, 66560, v105
    global_store_dwordx4 v105, v[108:111], s[22:23] sc1
    global_store_dwordx4 v105, v[108:111], s[22:23] offset:1024 sc1
    v_add_u32 v105, 66560, v105
    global_store_dwordx4 v105, v[108:111], s[22:23] sc1
    global_store_dwordx4 v105, v[108:111], s[22:23] offset:1024 sc1
    v_add_u32 v105, 66560, v105
    global_store_dwordx4 v105, v[108:111], s[22:23] sc1
    global_store_dwordx4 v105, v[108:111], s[22:23] offset:1024 sc1
    s_mov_b64 exec, 0xffff
    global_store_dwordx2 v106, v[108:109], s[22:23] sc1
    s_mov_b64 exec, -1
    v_mov_b32 v215, 1
    s_mov_b32 s94, s38
    s_cmp_lg_u32 s94, 0
    s_cbranch_scc1 L_b_noel
    s_mov_b64 exec, 1
    global_atomic_add v215, v214, v9, s[20:21] sc0
    s_mov_b64 exec, -1
L_b_noel:
    s_mov_b32 s86, 0
    s_mov_b32 s87, 0
    s_mov_b32 s88, 0
    s_mov_b32 s89, 0
    s_mov_b32 s90, 0
    s_mov_b32 s91, 0
    s_mov_b32 s92, 0
    s_mov_b32 s93, 0
    s_waitcnt lgkmcnt(0)
    s_mov_b32 s96, 0
    s_cmp_le_i32 s32, 0
    s_cselect_b32 s3, 1, 0
    s_cselect_b32 s32, 8192, s32
    s_or_b32 s96, s96, s3
    s_min_i32 s32, s32, 8192
    s_cmp_le_i32 s33, 0
    s_cselect_b32 s3, 2, 0
    s_cselect_b32 s33, 8192, s33
    s_or_b32 s96, s96, s3
    s_min_i32 s33, s33, 8192
    s_cmp_le_i32 s34, 0
    s_cselect_b32 s3, 4, 0
    s_cselect_b32 s34, 8192, s34
    s_or_b32 s96, s96, s3
    s_min_i32 s34, s34, 8192
    s_cmp_le_i32 s35, 0
    s_cselect_b32 s3, 8, 0
    s_cselect_b32 s35, 8192, s35
    s_or_b32 s96, s96, s3
    s_min_i32 s35, s35, 8192
    s_waitcnt vmcnt(9)
    s_sub_u32 s3, s32, 0
    v_sub_u32 v100, s3, v104
    v_med3_i32 v100, v100, 0, 16
    s_sub_u32 s3, s33, 0
    v_sub_u32 v101, s3, v104
    v_med3_i32 v101, v101, 0, 16
    s_sub_u32 s3, s34, 0
    v_sub_u32 v102, s3, v104
    v_med3_i32 v102, v102, 0, 16
    s_sub_u32 s3, s35, 0
    v_sub_u32 v103, s3, v104
    v_med3_i32 v103, v103, 0, 16
    v_cmp_lt_u32 s[52:53], 0, v100
    v_cmp_lt_u32 s[54:55], 0, v101
    v_cmp_lt_u32 s[56:57], 0, v102
    v_cmp_lt_u32 s[58:59], 0, v103
    v_lshlrev_b32 v101, 8, v101
    v_lshlrev_b32 v102, 16, v102
    v_lshlrev_b32 v103, 24, v103
    v_cmp_gt_i32 vcc, 0, v32
    v_add_u32 v113, 1280, v32
    s_nop 0
    v_cndmask_b32 v32, v32, v113, vcc
    v_min_u32 v32, 1279, v32
    v_cmp_gt_i32 vcc, 0, v34
    v_add_u32 v113, 1280, v34
    s_nop 0
    v_cndmask_b32 v34, v34, v113, vcc
    v_min_u32 v34, 1279, v34
    v_cmp_gt_i32 vcc, 0, v36
    v_add_u32 v113, 1280, v36
    s_nop 0
    v_cndmask_b32 v36, v36, v113, vcc
    v_min_u32 v36, 1279, v36
    v_cmp_gt_i32 vcc, 0, v38
    v_add_u32 v113, 1280, v38
    s_nop 0
    v_cndmask_b32 v38, v38, v113, vcc
    v_min_u32 v38, 1279, v38
    v_cmp_eq_u32 s[66:67], v32, v34
    v_cmp_eq_u32 s[68:69], v32, v36
    v_cmp_eq_u32 s[70:71], v32, v38
    v_cmp_eq_u32 s[72:73], v34, v36
    v_cmp_eq_u32 s[74:75], v34, v38
    v_cmp_eq_u32 s[76:77], v36, v38
    v_cndmask_b32 v113, 0, v101, s[66:67]
    v_or_b32 v33, v113, v100
    v_cndmask_b32 v113, 0, v102, s[68:69]
    v_or_b32 v33, v113, v33
    v_cndmask_b32 v113, 0, v103, s[70:71]
    v_or_b32 v33, v113, v33
    v_cndmask_b32 v113, 0, v102, s[72:73]
    v_or_b32 v35, v113, v101
    v_cndmask_b32 v113, 0, v103, s[74:75]
    v_or_b32 v35, v113, v35
    v_cndmask_b32 v113, 0, v103, s[76:77]
    v_or_b32 v37, v113, v102
    v_or_b32 v39, 96, v103
    s_and_b64 s[84:85], s[52:53], s[66:67]
    s_andn2_b64 s[60:61], s[54:55], s[84:85]
    s_and_b64 s[84:85], s[52:53], s[68:69]
    s_andn2_b64 s[62:63], s[56:57], s[84:85]
    s_and_b64 s[84:85], s[54:55], s[72:73]
    s_andn2_b64 s[62:63], s[62:63], s[84:85]
    s_and_b64 s[84:85], s[52:53], s[70:71]
    s_andn2_b64 s[64:65], s[58:59], s[84:85]
    s_and_b64 s[84:85], s[54:55], s[74:75]
    s_andn2_b64 s[64:65], s[64:65], s[84:85]
    s_and_b64 s[84:85], s[56:57], s[76:77]
    s_andn2_b64 s[64:65], s[64:65], s[84:85]
    s_and_b64 s[78:79], s[66:67], s[54:55]
    s_and_b64 s[84:85], s[68:69], s[56:57]
    s_or_b64 s[78:79], s[78:79], s[84:85]
    s_and_b64 s[84:85], s[70:71], s[58:59]
    s_or_b64 s[78:79], s[78:79], s[84:85]
    s_and_b64 s[80:81], s[72:73], s[56:57]
    s_and_b64 s[84:85], s[74:75], s[58:59]
    s_or_b64 s[80:81], s[80:81], s[84:85]
    s_and_b64 s[82:83], s[76:77], s[58:59]
    v_mov_b32 v113, 0
    v_mov_b32 v114, 128
    v_cndmask_b32 v113, v113, v114, s[78:79]
    v_or_b32 v33, v33, v113
    v_mov_b32 v113, 32
    v_mov_b32 v114, 128
    v_cndmask_b32 v113, v113, v114, s[80:81]
    v_or_b32 v35, v35, v113
    v_mov_b32 v113, 64
    v_mov_b32 v114, 128
    v_cndmask_b32 v113, v113, v114, s[82:83]
    v_or_b32 v37, v37, v113
    v_lshlrev_b32 v32, 17, v32
    v_cndmask_b32 v33, 0, v33, s[52:53]
    s_bcnt1_i32_b64 s3, s[52:53]
    s_add_u32 s86, s86, s3
    v_lshlrev_b32 v34, 17, v34
    v_cndmask_b32 v35, 0, v35, s[60:61]
    s_bcnt1_i32_b64 s3, s[60:61]
    s_add_u32 s87, s87, s3
    v_lshlrev_b32 v36, 17, v36
    v_cndmask_b32 v37, 0, v37, s[62:63]
    s_bcnt1_i32_b64 s3, s[62:63]
    s_add_u32 s88, s88, s3
    v_lshlrev_b32 v38, 17, v38
    v_cndmask_b32 v39, 0, v39, s[64:65]
    s_bcnt1_i32_b64 s3, s[64:65]
    s_add_u32 s89, s89, s3
    s_sub_u32 s3, s32, 1024
    v_sub_u32 v100, s3, v104
    v_med3_i32 v100, v100, 0, 16
    s_sub_u32 s3, s33, 1024
    v_sub_u32 v101, s3, v104
    v_med3_i32 v101, v101, 0, 16
    s_sub_u32 s3, s34, 1024
    v_sub_u32 v102, s3, v104
    v_med3_i32 v102, v102, 0, 16
    s_sub_u32 s3, s35, 1024
    v_sub_u32 v103, s3, v104
    v_med3_i32 v103, v103, 0, 16
    v_cmp_lt_u32 s[52:53], 0, v100
    v_cmp_lt_u32 s[54:55], 0, v101
    v_cmp_lt_u32 s[56:57], 0, v102
    v_cmp_lt_u32 s[58:59], 0, v103
    v_lshlrev_b32 v101, 8, v101
    v_lshlrev_b32 v102, 16, v102
    v_lshlrev_b32 v103, 24, v103
    v_cmp_gt_i32 vcc, 0, v40
    v_add_u32 v113, 1280, v40
    s_nop 0
    v_cndmask_b32 v40, v40, v113, vcc
    v_min_u32 v40, 1279, v40
    v_cmp_gt_i32 vcc, 0, v42
    v_add_u32 v113, 1280, v42
    s_nop 0
    v_cndmask_b32 v42, v42, v113, vcc
    v_min_u32 v42, 1279, v42
    v_cmp_gt_i32 vcc, 0, v44
    v_add_u32 v113, 1280, v44
    s_nop 0
    v_cndmask_b32 v44, v44, v113, vcc
    v_min_u32 v44, 1279, v44
    v_cmp_gt_i32 vcc, 0, v46
    v_add_u32 v113, 1280, v46
    s_nop 0
    v_cndmask_b32 v46, v46, v113, vcc
    v_min_u32 v46, 1279, v46
    v_cmp_eq_u32 s[66:67], v40, v42
    v_cmp_eq_u32 s[68:69], v40, v44
    v_cmp_eq_u32 s[70:71], v40, v46
    v_cmp_eq_u32 s[72:73], v42, v44
    v_cmp_eq_u32 s[74:75], v42, v46
    v_cmp_eq_u32 s[76:77], v44, v46
    v_cndmask_b32 v113, 0, v101, s[66:67]
    v_or_b32 v41, v113, v100
    v_cndmask_b32 v113, 0, v102, s[68:69]
    v_or_b32 v41, v113, v41
    v_cndmask_b32 v113, 0, v103, s[70:71]
    v_or_b32 v41, v113, v41
    v_cndmask_b32 v113, 0, v102, s[72:73]
    v_or_b32 v43, v113, v101
    v_cndmask_b32 v113, 0, v103, s[74:75]
    v_or_b32 v43, v113, v43
    v_cndmask_b32 v113, 0, v103, s[76:77]
    v_or_b32 v45, v113, v102
    v_or_b32 v47, 96, v103
    s_and_b64 s[84:85], s[52:53], s[66:67]
    s_andn2_b64 s[60:61], s[54:55], s[84:85]
    s_and_b64 s[84:85], s[52:53], s[68:69]
    s_andn2_b64 s[62:63], s[56:57], s[84:85]
    s_and_b64 s[84:85], s[54:55], s[72:73]
    s_andn2_b64 s[62:63], s[62:63], s[84:85]
    s_and_b64 s[84:85], s[52:53], s[70:71]
    s_andn2_b64 s[64:65], s[58:59], s[84:85]
    s_and_b64 s[84:85], s[54:55], s[74:75]
    s_andn2_b64 s[64:65], s[64:65], s[84:85]
    s_and_b64 s[84:85], s[56:57], s[76:77]
    s_andn2_b64 s[64:65], s[64:65], s[84:85]
    s_and_b64 s[78:79], s[66:67], s[54:55]
    s_and_b64 s[84:85], s[68:69], s[56:57]
    s_or_b64 s[78:79], s[78:79], s[84:85]
    s_and_b64 s[84:85], s[70:71], s[58:59]
    s_or_b64 s[78:79], s[78:79], s[84:85]
    s_and_b64 s[80:81], s[72:73], s[56:57]
    s_and_b64 s[84:85], s[74:75], s[58:59]
    s_or_b64 s[80:81], s[80:81], s[84:85]
    s_and_b64 s[82:83], s[76:77], s[58:59]
    v_mov_b32 v113, 0
    v_mov_b32 v114, 128
    v_cndmask_b32 v113, v113, v114, s[78:79]
    v_or_b32 v41, v41, v113
    v_mov_b32 v113, 32
    v_mov_b32 v114, 128
    v_cndmask_b32 v113, v113, v114, s[80:81]
    v_or_b32 v43, v43, v113
    v_mov_b32 v113, 64
    v_mov_b32 v114, 128
    v_cndmask_b32 v113, v113, v114, s[82:83]
    v_or_b32 v45, v45, v113
    v_lshlrev_b32 v40, 17, v40
    v_cndmask_b32 v41, 0, v41, s[52:53]
    s_bcnt1_i32_b64 s3, s[52:53]
    s_add_u32 s86, s86, s3
    v_lshlrev_b32 v42, 17, v42
    v_cndmask_b32 v43, 0, v43, s[60:61]
    s_bcnt1_i32_b64 s3, s[60:61]
    s_add_u32 s87, s87, s3
    v_lshlrev_b32 v44, 17, v44
    v_cndmask_b32 v45, 0, v45, s[62:63]
    s_bcnt1_i32_b64 s3, s[62:63]
    s_add_u32 s88, s88, s3
    v_lshlrev_b32 v46, 17, v46
    v_cndmask_b32 v47, 0, v47, s[64:65]
    s_bcnt1_i32_b64 s3, s[64:65]
    s_add_u32 s89, s89, s3
    s_sub_u32 s3, s32, 2048
    v_sub_u32 v100, s3, v104
    v_med3_i32 v100, v100, 0, 16
    s_sub_u32 s3, s33, 2048
    v_sub_u32 v101, s3, v104
    v_med3_i32 v101, v101, 0, 16
    s_sub_u32 s3, s34, 2048
    v_sub_u32 v102, s3, v104
    v_med3_i32 v102, v102, 0, 16
    s_sub_u32 s3, s35, 2048
    v_sub_u32 v103, s3, v104
    v_med3_i32 v103, v103, 0, 16
    v_cmp_lt_u32 s[52:53], 0, v100
    v_cmp_lt_u32 s[54:55], 0, v101
    v_cmp_lt_u32 s[56:57], 0, v102
    v_cmp_lt_u32 s[58:59], 0, v103
    v_lshlrev_b32 v101, 8, v101
    v_lshlrev_b32 v102, 16, v102
    v_lshlrev_b32 v103, 24, v103
    v_cmp_gt_i32 vcc, 0, v48
    v_add_u32 v113, 1280, v48
    s_nop 0
    v_cndmask_b32 v48, v48, v113, vcc
    v_min_u32 v48, 1279, v48
    v_cmp_gt_i32 vcc, 0, v50
    v_add_u32 v113, 1280, v50
    s_nop 0
    v_cndmask_b32 v50, v50, v113, vcc
    v_min_u32 v50, 1279, v50
    v_cmp_gt_i32 vcc, 0, v52
    v_add_u32 v113, 1280, v52
    s_nop 0
    v_cndmask_b32 v52, v52, v113, vcc
    v_min_u32 v52, 1279, v52
    v_cmp_gt_i32 vcc, 0, v54
    v_add_u32 v113, 1280, v54
    s_nop 0
    v_cndmask_b32 v54, v54, v113, vcc
    v_min_u32 v54, 1279, v54
    v_cmp_eq_u32 s[66:67], v48, v50
    v_cmp_eq_u32 s[68:69], v48, v52
    v_cmp_eq_u32 s[70:71], v48, v54
    v_cmp_eq_u32 s[72:73], v50, v52
    v_cmp_eq_u32 s[74:75], v50, v54
    v_cmp_eq_u32 s[76:77], v52, v54
    v_cndmask_b32 v113, 0, v101, s[66:67]
    v_or_b32 v49, v113, v100
    v_cndmask_b32 v113, 0, v102, s[68:69]
    v_or_b32 v49, v113, v49
    v_cndmask_b32 v113, 0, v103, s[70:71]
    v_or_b32 v49, v113, v49
    v_cndmask_b32 v113, 0, v102, s[72:73]
    v_or_b32 v51, v113, v101
    v_cndmask_b32 v113, 0, v103, s[74:75]
    v_or_b32 v51, v113, v51
    v_cndmask_b32 v113, 0, v103, s[76:77]
    v_or_b32 v53, v113, v102
    v_or_b32 v55, 96, v103
    s_and_b64 s[84:85], s[52:53], s[66:67]
    s_andn2_b64 s[60:61], s[54:55], s[84:85]
    s_and_b64 s[84:85], s[52:53], s[68:69]
    s_andn2_b64 s[62:63], s[56:57], s[84:85]
    s_and_b64 s[84:85], s[54:55], s[72:73]
    s_andn2_b64 s[62:63], s[62:63], s[84:85]
    s_and_b64 s[84:85], s[52:53], s[70:71]
    s_andn2_b64 s[64:65], s[58:59], s[84:85]
    s_and_b64 s[84:85], s[54:55], s[74:75]
    s_andn2_b64 s[64:65], s[64:65], s[84:85]
    s_and_b64 s[84:85], s[56:57], s[76:77]
    s_andn2_b64 s[64:65], s[64:65], s[84:85]
    s_and_b64 s[78:79], s[66:67], s[54:55]
    s_and_b64 s[84:85], s[68:69], s[56:57]
    s_or_b64 s[78:79], s[78:79], s[84:85]
    s_and_b64 s[84:85], s[70:71], s[58:59]
    s_or_b64 s[78:79], s[78:79], s[84:85]
    s_and_b64 s[80:81], s[72:73], s[56:57]
    s_and_b64 s[84:85], s[74:75], s[58:59]
    s_or_b64 s[80:81], s[80:81], s[84:85]
    s_and_b64 s[82:83], s[76:77], s[58:59]
    v_mov_b32 v113, 0
    v_mov_b32 v114, 128
    v_cndmask_b32 v113, v113, v114, s[78:79]
    v_or_b32 v49, v49, v113
    v_mov_b32 v113, 32
    v_mov_b32 v114, 128
    v_cndmask_b32 v113, v113, v114, s[80:81]
    v_or_b32 v51, v51, v113
    v_mov_b32 v113, 64
    v_mov_b32 v114, 128
    v_cndmask_b32 v113, v113, v114, s[82:83]
    v_or_b32 v53, v53, v113
    v_lshlrev_b32 v48, 17, v48
    v_cndmask_b32 v49, 0, v49, s[52:53]
    s_bcnt1_i32_b64 s3, s[52:53]
    s_add_u32 s86, s86, s3
    v_lshlrev_b32 v50, 17, v50
    v_cndmask_b32 v51, 0, v51, s[60:61]
    s_bcnt1_i32_b64 s3, s[60:61]
    s_add_u32 s87, s87, s3
    v_lshlrev_b32 v52, 17, v52
    v_cndmask_b32 v53, 0, v53, s[62:63]
    s_bcnt1_i32_b64 s3, s[62:63]
    s_add_u32 s88, s88, s3
    v_lshlrev_b32 v54, 17, v54
    v_cndmask_b32 v55, 0, v55, s[64:65]
    s_bcnt1_i32_b64 s3, s[64:65]
    s_add_u32 s89, s89, s3
    s_sub_u32 s3, s32, 3072
    v_sub_u32 v100, s3, v104
    v_med3_i32 v100, v100, 0, 16
    s_sub_u32 s3, s33, 3072
    v_sub_u32 v101, s3, v104
    v_med3_i32 v101, v101, 0, 16
    s_sub_u32 s3, s34, 3072
    v_sub_u32 v102, s3, v104
    v_med3_i32 v102, v102, 0, 16
    s_sub_u32 s3, s35, 3072
    v_sub_u32 v103, s3, v104
    v_med3_i32 v103, v103, 0, 16
    v_cmp_lt_u32 s[52:53], 0, v100
    v_cmp_lt_u32 s[54:55], 0, v101
    v_cmp_lt_u32 s[56:57], 0, v102
    v_cmp_lt_u32 s[58:59], 0, v103
    v_lshlrev_b32 v101, 8, v101
    v_lshlrev_b32 v102, 16, v102
    v_lshlrev_b32 v103, 24, v103
    v_cmp_gt_i32 vcc, 0, v56
    v_add_u32 v113, 1280, v56
    s_nop 0
    v_cndmask_b32 v56, v56, v113, vcc
    v_min_u32 v56, 1279, v56
    v_cmp_gt_i32 vcc, 0, v58
    v_add_u32 v113, 1280, v58
    s_nop 0
    v_cndmask_b32 v58, v58, v113, vcc
    v_min_u32 v58, 1279, v58
    v_cmp_gt_i32 vcc, 0, v60
    v_add_u32 v113, 1280, v60
    s_nop 0
    v_cndmask_b32 v60, v60, v113, vcc
    v_min_u32 v60, 1279, v60
    v_cmp_gt_i32 vcc, 0, v62
    v_add_u32 v113, 1280, v62
    s_nop 0
    v_cndmask_b32 v62, v62, v113, vcc
    v_min_u32 v62, 1279, v62
    v_cmp_eq_u32 s[66:67], v56, v58
    v_cmp_eq_u32 s[68:69], v56, v60
    v_cmp_eq_u32 s[70:71], v56, v62
    v_cmp_eq_u32 s[72:73], v58, v60
    v_cmp_eq_u32 s[74:75], v58, v62
    v_cmp_eq_u32 s[76:77], v60, v62
    v_cndmask_b32 v113, 0, v101, s[66:67]
    v_or_b32 v57, v113, v100
    v_cndmask_b32 v113, 0, v102, s[68:69]
    v_or_b32 v57, v113, v57
    v_cndmask_b32 v113, 0, v103, s[70:71]
    v_or_b32 v57, v113, v57
    v_cndmask_b32 v113, 0, v102, s[72:73]
    v_or_b32 v59, v113, v101
    v_cndmask_b32 v113, 0, v103, s[74:75]
    v_or_b32 v59, v113, v59
    v_cndmask_b32 v113, 0, v103, s[76:77]
    v_or_b32 v61, v113, v102
    v_or_b32 v63, 96, v103
    s_and_b64 s[84:85], s[52:53], s[66:67]
    s_andn2_b64 s[60:61], s[54:55], s[84:85]
    s_and_b64 s[84:85], s[52:53], s[68:69]
    s_andn2_b64 s[62:63], s[56:57], s[84:85]
    s_and_b64 s[84:85], s[54:55], s[72:73]
    s_andn2_b64 s[62:63], s[62:63], s[84:85]
    s_and_b64 s[84:85], s[52:53], s[70:71]
    s_andn2_b64 s[64:65], s[58:59], s[84:85]
    s_and_b64 s[84:85], s[54:55], s[74:75]
    s_andn2_b64 s[64:65], s[64:65], s[84:85]
    s_and_b64 s[84:85], s[56:57], s[76:77]
    s_andn2_b64 s[64:65], s[64:65], s[84:85]
    s_and_b64 s[78:79], s[66:67], s[54:55]
    s_and_b64 s[84:85], s[68:69], s[56:57]
    s_or_b64 s[78:79], s[78:79], s[84:85]
    s_and_b64 s[84:85], s[70:71], s[58:59]
    s_or_b64 s[78:79], s[78:79], s[84:85]
    s_and_b64 s[80:81], s[72:73], s[56:57]
    s_and_b64 s[84:85], s[74:75], s[58:59]
    s_or_b64 s[80:81], s[80:81], s[84:85]
    s_and_b64 s[82:83], s[76:77], s[58:59]
    v_mov_b32 v113, 0
    v_mov_b32 v114, 128
    v_cndmask_b32 v113, v113, v114, s[78:79]
    v_or_b32 v57, v57, v113
    v_mov_b32 v113, 32
    v_mov_b32 v114, 128
    v_cndmask_b32 v113, v113, v114, s[80:81]
    v_or_b32 v59, v59, v113
    v_mov_b32 v113, 64
    v_mov_b32 v114, 128
    v_cndmask_b32 v113, v113, v114, s[82:83]
    v_or_b32 v61, v61, v113
    v_lshlrev_b32 v56, 17, v56
    v_cndmask_b32 v57, 0, v57, s[52:53]
    s_bcnt1_i32_b64 s3, s[52:53]
    s_add_u32 s86, s86, s3
    v_lshlrev_b32 v58, 17, v58
    v_cndmask_b32 v59, 0, v59, s[60:61]
    s_bcnt1_i32_b64 s3, s[60:61]
    s_add_u32 s87, s87, s3
    v_lshlrev_b32 v60, 17, v60
    v_cndmask_b32 v61, 0, v61, s[62:63]
    s_bcnt1_i32_b64 s3, s[62:63]
    s_add_u32 s88, s88, s3
    v_lshlrev_b32 v62, 17, v62
    v_cndmask_b32 v63, 0, v63, s[64:65]
    s_bcnt1_i32_b64 s3, s[64:65]
    s_add_u32 s89, s89, s3
    s_sub_u32 s3, s32, 4096
    v_sub_u32 v100, s3, v104
    v_med3_i32 v100, v100, 0, 16
    s_sub_u32 s3, s33, 4096
    v_sub_u32 v101, s3, v104
    v_med3_i32 v101, v101, 0, 16
    s_sub_u32 s3, s34, 4096
    v_sub_u32 v102, s3, v104
    v_med3_i32 v102, v102, 0, 16
    s_sub_u32 s3, s35, 4096
    v_sub_u32 v103, s3, v104
    v_med3_i32 v103, v103, 0, 16
    v_cmp_lt_u32 s[52:53], 0, v100
    v_cmp_lt_u32 s[54:55], 0, v101
    v_cmp_lt_u32 s[56:57], 0, v102
    v_cmp_lt_u32 s[58:59], 0, v103
    v_lshlrev_b32 v101, 8, v101
    v_lshlrev_b32 v102, 16, v102
    v_lshlrev_b32 v103, 24, v103
    v_cmp_gt_i32 vcc, 0, v64
    v_add_u32 v113, 1280, v64
    s_nop 0
    v_cndmask_b32 v64, v64, v113, vcc
    v_min_u32 v64, 1279, v64
    v_cmp_gt_i32 vcc, 0, v66
    v_add_u32 v113, 1280, v66
    s_nop 0
    v_cndmask_b32 v66, v66, v113, vcc
    v_min_u32 v66, 1279, v66
    v_cmp_gt_i32 vcc, 0, v68
    v_add_u32 v113, 1280, v68
    s_nop 0
    v_cndmask_b32 v68, v68, v113, vcc
    v_min_u32 v68, 1279, v68
    v_cmp_gt_i32 vcc, 0, v70
    v_add_u32 v113, 1280, v70
    s_nop 0
    v_cndmask_b32 v70, v70, v113, vcc
    v_min_u32 v70, 1279, v70
    v_cmp_eq_u32 s[66:67], v64, v66
    v_cmp_eq_u32 s[68:69], v64, v68
    v_cmp_eq_u32 s[70:71], v64, v70
    v_cmp_eq_u32 s[72:73], v66, v68
    v_cmp_eq_u32 s[74:75], v66, v70
    v_cmp_eq_u32 s[76:77], v68, v70
    v_cndmask_b32 v113, 0, v101, s[66:67]
    v_or_b32 v65, v113, v100
    v_cndmask_b32 v113, 0, v102, s[68:69]
    v_or_b32 v65, v113, v65
    v_cndmask_b32 v113, 0, v103, s[70:71]
    v_or_b32 v65, v113, v65
    v_cndmask_b32 v113, 0, v102, s[72:73]
    v_or_b32 v67, v113, v101
    v_cndmask_b32 v113, 0, v103, s[74:75]
    v_or_b32 v67, v113, v67
    v_cndmask_b32 v113, 0, v103, s[76:77]
    v_or_b32 v69, v113, v102
    v_or_b32 v71, 96, v103
    s_and_b64 s[84:85], s[52:53], s[66:67]
    s_andn2_b64 s[60:61], s[54:55], s[84:85]
    s_and_b64 s[84:85], s[52:53], s[68:69]
    s_andn2_b64 s[62:63], s[56:57], s[84:85]
    s_and_b64 s[84:85], s[54:55], s[72:73]
    s_andn2_b64 s[62:63], s[62:63], s[84:85]
    s_and_b64 s[84:85], s[52:53], s[70:71]
    s_andn2_b64 s[64:65], s[58:59], s[84:85]
    s_and_b64 s[84:85], s[54:55], s[74:75]
    s_andn2_b64 s[64:65], s[64:65], s[84:85]
    s_and_b64 s[84:85], s[56:57], s[76:77]
    s_andn2_b64 s[64:65], s[64:65], s[84:85]
    s_and_b64 s[78:79], s[66:67], s[54:55]
    s_and_b64 s[84:85], s[68:69], s[56:57]
    s_or_b64 s[78:79], s[78:79], s[84:85]
    s_and_b64 s[84:85], s[70:71], s[58:59]
    s_or_b64 s[78:79], s[78:79], s[84:85]
    s_and_b64 s[80:81], s[72:73], s[56:57]
    s_and_b64 s[84:85], s[74:75], s[58:59]
    s_or_b64 s[80:81], s[80:81], s[84:85]
    s_and_b64 s[82:83], s[76:77], s[58:59]
    v_mov_b32 v113, 0
    v_mov_b32 v114, 128
    v_cndmask_b32 v113, v113, v114, s[78:79]
    v_or_b32 v65, v65, v113
    v_mov_b32 v113, 32
    v_mov_b32 v114, 128
    v_cndmask_b32 v113, v113, v114, s[80:81]
    v_or_b32 v67, v67, v113
    v_mov_b32 v113, 64
    v_mov_b32 v114, 128
    v_cndmask_b32 v113, v113, v114, s[82:83]
    v_or_b32 v69, v69, v113
    v_lshlrev_b32 v64, 17, v64
    v_cndmask_b32 v65, 0, v65, s[52:53]
    s_bcnt1_i32_b64 s3, s[52:53]
    s_add_u32 s90, s90, s3
    v_lshlrev_b32 v66, 17, v66
    v_cndmask_b32 v67, 0, v67, s[60:61]
    s_bcnt1_i32_b64 s3, s[60:61]
    s_add_u32 s91, s91, s3
    v_lshlrev_b32 v68, 17, v68
    v_cndmask_b32 v69, 0, v69, s[62:63]
    s_bcnt1_i32_b64 s3, s[62:63]
    s_add_u32 s92, s92, s3
    v_lshlrev_b32 v70, 17, v70
    v_cndmask_b32 v71, 0, v71, s[64:65]
    s_bcnt1_i32_b64 s3, s[64:65]
    s_add_u32 s93, s93, s3
    s_sub_u32 s3, s32, 5120
    v_sub_u32 v100, s3, v104
    v_med3_i32 v100, v100, 0, 16
    s_sub_u32 s3, s33, 5120
    v_sub_u32 v101, s3, v104
    v_med3_i32 v101, v101, 0, 16
    s_sub_u32 s3, s34, 5120
    v_sub_u32 v102, s3, v104
    v_med3_i32 v102, v102, 0, 16
    s_sub_u32 s3, s35, 5120
    v_sub_u32 v103, s3, v104
    v_med3_i32 v103, v103, 0, 16
    v_cmp_lt_u32 s[52:53], 0, v100
    v_cmp_lt_u32 s[54:55], 0, v101
    v_cmp_lt_u32 s[56:57], 0, v102
    v_cmp_lt_u32 s[58:59], 0, v103
    v_lshlrev_b32 v101, 8, v101
    v_lshlrev_b32 v102, 16, v102
    v_lshlrev_b32 v103, 24, v103
    v_cmp_gt_i32 vcc, 0, v72
    v_add_u32 v113, 1280, v72
    s_nop 0
    v_cndmask_b32 v72, v72, v113, vcc
    v_min_u32 v72, 1279, v72
    v_cmp_gt_i32 vcc, 0, v74
    v_add_u32 v113, 1280, v74
    s_nop 0
    v_cndmask_b32 v74, v74, v113, vcc
    v_min_u32 v74, 1279, v74
    v_cmp_gt_i32 vcc, 0, v76
    v_add_u32 v113, 1280, v76
    s_nop 0
    v_cndmask_b32 v76, v76, v113, vcc
    v_min_u32 v76, 1279, v76
    v_cmp_gt_i32 vcc, 0, v78
    v_add_u32 v113, 1280, v78
    s_nop 0
    v_cndmask_b32 v78, v78, v113, vcc
    v_min_u32 v78, 1279, v78
    v_cmp_eq_u32 s[66:67], v72, v74
    v_cmp_eq_u32 s[68:69], v72, v76
    v_cmp_eq_u32 s[70:71], v72, v78
    v_cmp_eq_u32 s[72:73], v74, v76
    v_cmp_eq_u32 s[74:75], v74, v78
    v_cmp_eq_u32 s[76:77], v76, v78
    v_cndmask_b32 v113, 0, v101, s[66:67]
    v_or_b32 v73, v113, v100
    v_cndmask_b32 v113, 0, v102, s[68:69]
    v_or_b32 v73, v113, v73
    v_cndmask_b32 v113, 0, v103, s[70:71]
    v_or_b32 v73, v113, v73
    v_cndmask_b32 v113, 0, v102, s[72:73]
    v_or_b32 v75, v113, v101
    v_cndmask_b32 v113, 0, v103, s[74:75]
    v_or_b32 v75, v113, v75
    v_cndmask_b32 v113, 0, v103, s[76:77]
    v_or_b32 v77, v113, v102
    v_or_b32 v79, 96, v103
    s_and_b64 s[84:85], s[52:53], s[66:67]
    s_andn2_b64 s[60:61], s[54:55], s[84:85]
    s_and_b64 s[84:85], s[52:53], s[68:69]
    s_andn2_b64 s[62:63], s[56:57], s[84:85]
    s_and_b64 s[84:85], s[54:55], s[72:73]
    s_andn2_b64 s[62:63], s[62:63], s[84:85]
    s_and_b64 s[84:85], s[52:53], s[70:71]
    s_andn2_b64 s[64:65], s[58:59], s[84:85]
    s_and_b64 s[84:85], s[54:55], s[74:75]
    s_andn2_b64 s[64:65], s[64:65], s[84:85]
    s_and_b64 s[84:85], s[56:57], s[76:77]
    s_andn2_b64 s[64:65], s[64:65], s[84:85]
    s_and_b64 s[78:79], s[66:67], s[54:55]
    s_and_b64 s[84:85], s[68:69], s[56:57]
    s_or_b64 s[78:79], s[78:79], s[84:85]
    s_and_b64 s[84:85], s[70:71], s[58:59]
    s_or_b64 s[78:79], s[78:79], s[84:85]
    s_and_b64 s[80:81], s[72:73], s[56:57]
    s_and_b64 s[84:85], s[74:75], s[58:59]
    s_or_b64 s[80:81], s[80:81], s[84:85]
    s_and_b64 s[82:83], s[76:77], s[58:59]
    v_mov_b32 v113, 0
    v_mov_b32 v114, 128
    v_cndmask_b32 v113, v113, v114, s[78:79]
    v_or_b32 v73, v73, v113
    v_mov_b32 v113, 32
    v_mov_b32 v114, 128
    v_cndmask_b32 v113, v113, v114, s[80:81]
    v_or_b32 v75, v75, v113
    v_mov_b32 v113, 64
    v_mov_b32 v114, 128
    v_cndmask_b32 v113, v113, v114, s[82:83]
    v_or_b32 v77, v77, v113
    v_lshlrev_b32 v72, 17, v72
    v_cndmask_b32 v73, 0, v73, s[52:53]
    s_bcnt1_i32_b64 s3, s[52:53]
    s_add_u32 s90, s90, s3
    v_lshlrev_b32 v74, 17, v74
    v_cndmask_b32 v75, 0, v75, s[60:61]
    s_bcnt1_i32_b64 s3, s[60:61]
    s_add_u32 s91, s91, s3
    v_lshlrev_b32 v76, 17, v76
    v_cndmask_b32 v77, 0, v77, s[62:63]
    s_bcnt1_i32_b64 s3, s[62:63]
    s_add_u32 s92, s92, s3
    v_lshlrev_b32 v78, 17, v78
    v_cndmask_b32 v79, 0, v79, s[64:65]
    s_bcnt1_i32_b64 s3, s[64:65]
    s_add_u32 s93, s93, s3
    s_sub_u32 s3, s32, 6144
    v_sub_u32 v100, s3, v104
    v_med3_i32 v100, v100, 0, 16
    s_sub_u32 s3, s33, 6144
    v_sub_u32 v101, s3, v104
    v_med3_i32 v101, v101, 0, 16
    s_sub_u32 s3, s34, 6144
    v_sub_u32 v102, s3, v104
    v_med3_i32 v102, v102, 0, 16
    s_sub_u32 s3, s35, 6144
    v_sub_u32 v103, s3, v104
    v_med3_i32 v103, v103, 0, 16
    v_cmp_lt_u32 s[52:53], 0, v100
    v_cmp_lt_u32 s[54:55], 0, v101
    v_cmp_lt_u32 s[56:57], 0, v102
    v_cmp_lt_u32 s[58:59], 0, v103
    v_lshlrev_b32 v101, 8, v101
    v_lshlrev_b32 v102, 16, v102
    v_lshlrev_b32 v103, 24, v103
    v_cmp_gt_i32 vcc, 0, v80
    v_add_u32 v113, 1280, v80
    s_nop 0
    v_cndmask_b32 v80, v80, v113, vcc
    v_min_u32 v80, 1279, v80
    v_cmp_gt_i32 vcc, 0, v82
    v_add_u32 v113, 1280, v82
    s_nop 0
    v_cndmask_b32 v82, v82, v113, vcc
    v_min_u32 v82, 1279, v82
    v_cmp_gt_i32 vcc, 0, v84
    v_add_u32 v113, 1280, v84
    s_nop 0
    v_cndmask_b32 v84, v84, v113, vcc
    v_min_u32 v84, 1279, v84
    v_cmp_gt_i32 vcc, 0, v86
    v_add_u32 v113, 1280, v86
    s_nop 0
    v_cndmask_b32 v86, v86, v113, vcc
    v_min_u32 v86, 1279, v86
    v_cmp_eq_u32 s[66:67], v80, v82
    v_cmp_eq_u32 s[68:69], v80, v84
    v_cmp_eq_u32 s[70:71], v80, v86
    v_cmp_eq_u32 s[72:73], v82, v84
    v_cmp_eq_u32 s[74:75], v82, v86
    v_cmp_eq_u32 s[76:77], v84, v86
    v_cndmask_b32 v113, 0, v101, s[66:67]
    v_or_b32 v81, v113, v100
    v_cndmask_b32 v113, 0, v102, s[68:69]
    v_or_b32 v81, v113, v81
    v_cndmask_b32 v113, 0, v103, s[70:71]
    v_or_b32 v81, v113, v81
    v_cndmask_b32 v113, 0, v102, s[72:73]
    v_or_b32 v83, v113, v101
    v_cndmask_b32 v113, 0, v103, s[74:75]
    v_or_b32 v83, v113, v83
    v_cndmask_b32 v113, 0, v103, s[76:77]
    v_or_b32 v85, v113, v102
    v_or_b32 v87, 96, v103
    s_and_b64 s[84:85], s[52:53], s[66:67]
    s_andn2_b64 s[60:61], s[54:55], s[84:85]
    s_and_b64 s[84:85], s[52:53], s[68:69]
    s_andn2_b64 s[62:63], s[56:57], s[84:85]
    s_and_b64 s[84:85], s[54:55], s[72:73]
    s_andn2_b64 s[62:63], s[62:63], s[84:85]
    s_and_b64 s[84:85], s[52:53], s[70:71]
    s_andn2_b64 s[64:65], s[58:59], s[84:85]
    s_and_b64 s[84:85], s[54:55], s[74:75]
    s_andn2_b64 s[64:65], s[64:65], s[84:85]
    s_and_b64 s[84:85], s[56:57], s[76:77]
    s_andn2_b64 s[64:65], s[64:65], s[84:85]
    s_and_b64 s[78:79], s[66:67], s[54:55]
    s_and_b64 s[84:85], s[68:69], s[56:57]
    s_or_b64 s[78:79], s[78:79], s[84:85]
    s_and_b64 s[84:85], s[70:71], s[58:59]
    s_or_b64 s[78:79], s[78:79], s[84:85]
    s_and_b64 s[80:81], s[72:73], s[56:57]
    s_and_b64 s[84:85], s[74:75], s[58:59]
    s_or_b64 s[80:81], s[80:81], s[84:85]
    s_and_b64 s[82:83], s[76:77], s[58:59]
    v_mov_b32 v113, 0
    v_mov_b32 v114, 128
    v_cndmask_b32 v113, v113, v114, s[78:79]
    v_or_b32 v81, v81, v113
    v_mov_b32 v113, 32
    v_mov_b32 v114, 128
    v_cndmask_b32 v113, v113, v114, s[80:81]
    v_or_b32 v83, v83, v113
    v_mov_b32 v113, 64
    v_mov_b32 v114, 128
    v_cndmask_b32 v113, v113, v114, s[82:83]
    v_or_b32 v85, v85, v113
    v_lshlrev_b32 v80, 17, v80
    v_cndmask_b32 v81, 0, v81, s[52:53]
    s_bcnt1_i32_b64 s3, s[52:53]
    s_add_u32 s90, s90, s3
    v_lshlrev_b32 v82, 17, v82
    v_cndmask_b32 v83, 0, v83, s[60:61]
    s_bcnt1_i32_b64 s3, s[60:61]
    s_add_u32 s91, s91, s3
    v_lshlrev_b32 v84, 17, v84
    v_cndmask_b32 v85, 0, v85, s[62:63]
    s_bcnt1_i32_b64 s3, s[62:63]
    s_add_u32 s92, s92, s3
    v_lshlrev_b32 v86, 17, v86
    v_cndmask_b32 v87, 0, v87, s[64:65]
    s_bcnt1_i32_b64 s3, s[64:65]
    s_add_u32 s93, s93, s3
    s_sub_u32 s3, s32, 7168
    v_sub_u32 v100, s3, v104
    v_med3_i32 v100, v100, 0, 16
    s_sub_u32 s3, s33, 7168
    v_sub_u32 v101, s3, v104
    v_med3_i32 v101, v101, 0, 16
    s_sub_u32 s3, s34, 7168
    v_sub_u32 v102, s3, v104
    v_med3_i32 v102, v102, 0, 16
    s_sub_u32 s3, s35, 7168
    v_sub_u32 v103, s3, v104
    v_med3_i32 v103, v103, 0, 16
    v_cmp_lt_u32 s[52:53], 0, v100
    v_cmp_lt_u32 s[54:55], 0, v101
    v_cmp_lt_u32 s[56:57], 0, v102
    v_cmp_lt_u32 s[58:59], 0, v103
    v_lshlrev_b32 v101, 8, v101
    v_lshlrev_b32 v102, 16, v102
    v_lshlrev_b32 v103, 24, v103
    v_cmp_gt_i32 vcc, 0, v88
    v_add_u32 v113, 1280, v88
    s_nop 0
    v_cndmask_b32 v88, v88, v113, vcc
    v_min_u32 v88, 1279, v88
    v_cmp_gt_i32 vcc, 0, v90
    v_add_u32 v113, 1280, v90
    s_nop 0
    v_cndmask_b32 v90, v90, v113, vcc
    v_min_u32 v90, 1279, v90
    v_cmp_gt_i32 vcc, 0, v92
    v_add_u32 v113, 1280, v92
    s_nop 0
    v_cndmask_b32 v92, v92, v113, vcc
    v_min_u32 v92, 1279, v92
    v_cmp_gt_i32 vcc, 0, v94
    v_add_u32 v113, 1280, v94
    s_nop 0
    v_cndmask_b32 v94, v94, v113, vcc
    v_min_u32 v94, 1279, v94
    v_cmp_eq_u32 s[66:67], v88, v90
    v_cmp_eq_u32 s[68:69], v88, v92
    v_cmp_eq_u32 s[70:71], v88, v94
    v_cmp_eq_u32 s[72:73], v90, v92
    v_cmp_eq_u32 s[74:75], v90, v94
    v_cmp_eq_u32 s[76:77], v92, v94
    v_cndmask_b32 v113, 0, v101, s[66:67]
    v_or_b32 v89, v113, v100
    v_cndmask_b32 v113, 0, v102, s[68:69]
    v_or_b32 v89, v113, v89
    v_cndmask_b32 v113, 0, v103, s[70:71]
    v_or_b32 v89, v113, v89
    v_cndmask_b32 v113, 0, v102, s[72:73]
    v_or_b32 v91, v113, v101
    v_cndmask_b32 v113, 0, v103, s[74:75]
    v_or_b32 v91, v113, v91
    v_cndmask_b32 v113, 0, v103, s[76:77]
    v_or_b32 v93, v113, v102
    v_or_b32 v95, 96, v103
    s_and_b64 s[84:85], s[52:53], s[66:67]
    s_andn2_b64 s[60:61], s[54:55], s[84:85]
    s_and_b64 s[84:85], s[52:53], s[68:69]
    s_andn2_b64 s[62:63], s[56:57], s[84:85]
    s_and_b64 s[84:85], s[54:55], s[72:73]
    s_andn2_b64 s[62:63], s[62:63], s[84:85]
    s_and_b64 s[84:85], s[52:53], s[70:71]
    s_andn2_b64 s[64:65], s[58:59], s[84:85]
    s_and_b64 s[84:85], s[54:55], s[74:75]
    s_andn2_b64 s[64:65], s[64:65], s[84:85]
    s_and_b64 s[84:85], s[56:57], s[76:77]
    s_andn2_b64 s[64:65], s[64:65], s[84:85]
    s_and_b64 s[78:79], s[66:67], s[54:55]
    s_and_b64 s[84:85], s[68:69], s[56:57]
    s_or_b64 s[78:79], s[78:79], s[84:85]
    s_and_b64 s[84:85], s[70:71], s[58:59]
    s_or_b64 s[78:79], s[78:79], s[84:85]
    s_and_b64 s[80:81], s[72:73], s[56:57]
    s_and_b64 s[84:85], s[74:75], s[58:59]
    s_or_b64 s[80:81], s[80:81], s[84:85]
    s_and_b64 s[82:83], s[76:77], s[58:59]
    v_mov_b32 v113, 0
    v_mov_b32 v114, 128
    v_cndmask_b32 v113, v113, v114, s[78:79]
    v_or_b32 v89, v89, v113
    v_mov_b32 v113, 32
    v_mov_b32 v114, 128
    v_cndmask_b32 v113, v113, v114, s[80:81]
    v_or_b32 v91, v91, v113
    v_mov_b32 v113, 64
    v_mov_b32 v114, 128
    v_cndmask_b32 v113, v113, v114, s[82:83]
    v_or_b32 v93, v93, v113
    v_lshlrev_b32 v88, 17, v88
    v_cndmask_b32 v89, 0, v89, s[52:53]
    s_bcnt1_i32_b64 s3, s[52:53]
    s_add_u32 s90, s90, s3
    v_lshlrev_b32 v90, 17, v90
    v_cndmask_b32 v91, 0, v91, s[60:61]
    s_bcnt1_i32_b64 s3, s[60:61]
    s_add_u32 s91, s91, s3
    v_lshlrev_b32 v92, 17, v92
    v_cndmask_b32 v93, 0, v93, s[62:63]
    s_bcnt1_i32_b64 s3, s[62:63]
    s_add_u32 s92, s92, s3
    v_lshlrev_b32 v94, 17, v94
    v_cndmask_b32 v95, 0, v95, s[64:65]
    s_bcnt1_i32_b64 s3, s[64:65]
    s_add_u32 s93, s93, s3
    s_mov_b32 s4, 0
    s_mov_b32 s3, s86
    s_mov_b32 s86, s4
    s_add_u32 s4, s4, s3
    s_mov_b32 s3, s87
    s_mov_b32 s87, s4
    s_add_u32 s4, s4, s3
    s_mov_b32 s3, s88
    s_mov_b32 s88, s4
    s_add_u32 s4, s4, s3
    s_mov_b32 s3, s89
    s_mov_b32 s89, s4
    s_add_u32 s4, s4, s3
    s_mov_b32 s3, s90
    s_mov_b32 s90, s4
    s_add_u32 s4, s4, s3
    s_mov_b32 s3, s91
    s_mov_b32 s91, s4
    s_add_u32 s4, s4, s3
    s_mov_b32 s3, s92
    s_mov_b32 s92, s4
    s_add_u32 s4, s4, s3
    s_mov_b32 s3, s93
    s_mov_b32 s93, s4
    s_add_u32 s4, s4, s3
    s_add_u32 s95, s4, 1
    v_cmp_ne_u32 s[84:85], 0, v33
    s_nop 1
    v_mbcnt_lo_u32_b32 v113, s84, 0
    v_mbcnt_hi_u32_b32 v113, s85, v113
    v_add_lshl_u32 v113, v113, s86, 3
    s_bcnt1_i32_b64 s3, s[84:85]
    s_mov_b64 exec, s[84:85]
    ds_write_b64 v113, v[32:33] offset:256
    s_mov_b64 exec, -1
    s_add_u32 s86, s86, s3
    v_cmp_ne_u32 s[84:85], 0, v35
    s_nop 1
    v_mbcnt_lo_u32_b32 v113, s84, 0
    v_mbcnt_hi_u32_b32 v113, s85, v113
    v_add_lshl_u32 v113, v113, s87, 3
    s_bcnt1_i32_b64 s3, s[84:85]
    s_mov_b64 exec, s[84:85]
    ds_write_b64 v113, v[34:35] offset:256
    s_mov_b64 exec, -1
    s_add_u32 s87, s87, s3
    v_cmp_ne_u32 s[84:85], 0, v37
    s_nop 1
    v_mbcnt_lo_u32_b32 v113, s84, 0
    v_mbcnt_hi_u32_b32 v113, s85, v113
    v_add_lshl_u32 v113, v113, s88, 3
    s_bcnt1_i32_b64 s3, s[84:85]
    s_mov_b64 exec, s[84:85]
    ds_write_b64 v113, v[36:37] offset:256
    s_mov_b64 exec, -1
    s_add_u32 s88, s88, s3
    v_cmp_ne_u32 s[84:85], 0, v39
    s_nop 1
    v_mbcnt_lo_u32_b32 v113, s84, 0
    v_mbcnt_hi_u32_b32 v113, s85, v113
    v_add_lshl_u32 v113, v113, s89, 3
    s_bcnt1_i32_b64 s3, s[84:85]
    s_mov_b64 exec, s[84:85]
    ds_write_b64 v113, v[38:39] offset:256
    s_mov_b64 exec, -1
    s_add_u32 s89, s89, s3
    v_cmp_ne_u32 s[84:85], 0, v41
    s_nop 1
    v_mbcnt_lo_u32_b32 v113, s84, 0
    v_mbcnt_hi_u32_b32 v113, s85, v113
    v_add_lshl_u32 v113, v113, s86, 3
    s_bcnt1_i32_b64 s3, s[84:85]
    s_mov_b64 exec, s[84:85]
    ds_write_b64 v113, v[40:41] offset:256
    s_mov_b64 exec, -1
    s_add_u32 s86, s86, s3
    v_cmp_ne_u32 s[84:85], 0, v43
    s_nop 1
    v_mbcnt_lo_u32_b32 v113, s84, 0
    v_mbcnt_hi_u32_b32 v113, s85, v113
    v_add_lshl_u32 v113, v113, s87, 3
    s_bcnt1_i32_b64 s3, s[84:85]
    s_mov_b64 exec, s[84:85]
    ds_write_b64 v113, v[42:43] offset:256
    s_mov_b64 exec, -1
    s_add_u32 s87, s87, s3
    v_cmp_ne_u32 s[84:85], 0, v45
    s_nop 1
    v_mbcnt_lo_u32_b32 v113, s84, 0
    v_mbcnt_hi_u32_b32 v113, s85, v113
    v_add_lshl_u32 v113, v113, s88, 3
    s_bcnt1_i32_b64 s3, s[84:85]
    s_mov_b64 exec, s[84:85]
    ds_write_b64 v113, v[44:45] offset:256
    s_mov_b64 exec, -1
    s_add_u32 s88, s88, s3
    v_cmp_ne_u32 s[84:85], 0, v47
    s_nop 1
    v_mbcnt_lo_u32_b32 v113, s84, 0
    v_mbcnt_hi_u32_b32 v113, s85, v113
    v_add_lshl_u32 v113, v113, s89, 3
    s_bcnt1_i32_b64 s3, s[84:85]
    s_mov_b64 exec, s[84:85]
    ds_write_b64 v113, v[46:47] offset:256
    s_mov_b64 exec, -1
    s_add_u32 s89, s89, s3
    v_cmp_ne_u32 s[84:85], 0, v49
    s_nop 1
    v_mbcnt_lo_u32_b32 v113, s84, 0
    v_mbcnt_hi_u32_b32 v113, s85, v113
    v_add_lshl_u32 v113, v113, s86, 3
    s_bcnt1_i32_b64 s3, s[84:85]
    s_mov_b64 exec, s[84:85]
    ds_write_b64 v113, v[48:49] offset:256
    s_mov_b64 exec, -1
    s_add_u32 s86, s86, s3
    v_cmp_ne_u32 s[84:85], 0, v51
    s_nop 1
    v_mbcnt_lo_u32_b32 v113, s84, 0
    v_mbcnt_hi_u32_b32 v113, s85, v113
    v_add_lshl_u32 v113, v113, s87, 3
    s_bcnt1_i32_b64 s3, s[84:85]
    s_mov_b64 exec, s[84:85]
    ds_write_b64 v113, v[50:51] offset:256
    s_mov_b64 exec, -1
    s_add_u32 s87, s87, s3
    v_cmp_ne_u32 s[84:85], 0, v53
    s_nop 1
    v_mbcnt_lo_u32_b32 v113, s84, 0
    v_mbcnt_hi_u32_b32 v113, s85, v113
    v_add_lshl_u32 v113, v113, s88, 3
    s_bcnt1_i32_b64 s3, s[84:85]
    s_mov_b64 exec, s[84:85]
    ds_write_b64 v113, v[52:53] offset:256
    s_mov_b64 exec, -1
    s_add_u32 s88, s88, s3
    v_cmp_ne_u32 s[84:85], 0, v55
    s_nop 1
    v_mbcnt_lo_u32_b32 v113, s84, 0
    v_mbcnt_hi_u32_b32 v113, s85, v113
    v_add_lshl_u32 v113, v113, s89, 3
    s_bcnt1_i32_b64 s3, s[84:85]
    s_mov_b64 exec, s[84:85]
    ds_write_b64 v113, v[54:55] offset:256
    s_mov_b64 exec, -1
    s_add_u32 s89, s89, s3
    v_cmp_ne_u32 s[84:85], 0, v57
    s_nop 1
    v_mbcnt_lo_u32_b32 v113, s84, 0
    v_mbcnt_hi_u32_b32 v113, s85, v113
    v_add_lshl_u32 v113, v113, s86, 3
    s_bcnt1_i32_b64 s3, s[84:85]
    s_mov_b64 exec, s[84:85]
    ds_write_b64 v113, v[56:57] offset:256
    s_mov_b64 exec, -1
    s_add_u32 s86, s86, s3
    v_cmp_ne_u32 s[84:85], 0, v59
    s_nop 1
    v_mbcnt_lo_u32_b32 v113, s84, 0
    v_mbcnt_hi_u32_b32 v113, s85, v113
    v_add_lshl_u32 v113, v113, s87, 3
    s_bcnt1_i32_b64 s3, s[84:85]
    s_mov_b64 exec, s[84:85]
    ds_write_b64 v113, v[58:59] offset:256
    s_mov_b64 exec, -1
    s_add_u32 s87, s87, s3
    v_cmp_ne_u32 s[84:85], 0, v61
    s_nop 1
    v_mbcnt_lo_u32_b32 v113, s84, 0
    v_mbcnt_hi_u32_b32 v113, s85, v113
    v_add_lshl_u32 v113, v113, s88, 3
    s_bcnt1_i32_b64 s3, s[84:85]
    s_mov_b64 exec, s[84:85]
    ds_write_b64 v113, v[60:61] offset:256
    s_mov_b64 exec, -1
    s_add_u32 s88, s88, s3
    v_cmp_ne_u32 s[84:85], 0, v63
    s_nop 1
    v_mbcnt_lo_u32_b32 v113, s84, 0
    v_mbcnt_hi_u32_b32 v113, s85, v113
    v_add_lshl_u32 v113, v113, s89, 3
    s_bcnt1_i32_b64 s3, s[84:85]
    s_mov_b64 exec, s[84:85]
    ds_write_b64 v113, v[62:63] offset:256
    s_mov_b64 exec, -1
    s_add_u32 s89, s89, s3
    v_cmp_ne_u32 s[84:85], 0, v65
    s_nop 1
    v_mbcnt_lo_u32_b32 v113, s84, 0
    v_mbcnt_hi_u32_b32 v113, s85, v113
    v_add_lshl_u32 v113, v113, s90, 3
    s_bcnt1_i32_b64 s3, s[84:85]
    s_mov_b64 exec, s[84:85]
    ds_write_b64 v113, v[64:65] offset:256
    s_mov_b64 exec, -1
    s_add_u32 s90, s90, s3
    v_cmp_ne_u32 s[84:85], 0, v67
    s_nop 1
    v_mbcnt_lo_u32_b32 v113, s84, 0
    v_mbcnt_hi_u32_b32 v113, s85, v113
    v_add_lshl_u32 v113, v113, s91, 3
    s_bcnt1_i32_b64 s3, s[84:85]
    s_mov_b64 exec, s[84:85]
    ds_write_b64 v113, v[66:67] offset:256
    s_mov_b64 exec, -1
    s_add_u32 s91, s91, s3
    v_cmp_ne_u32 s[84:85], 0, v69
    s_nop 1
    v_mbcnt_lo_u32_b32 v113, s84, 0
    v_mbcnt_hi_u32_b32 v113, s85, v113
    v_add_lshl_u32 v113, v113, s92, 3
    s_bcnt1_i32_b64 s3, s[84:85]
    s_mov_b64 exec, s[84:85]
    ds_write_b64 v113, v[68:69] offset:256
    s_mov_b64 exec, -1
    s_add_u32 s92, s92, s3
    v_cmp_ne_u32 s[84:85], 0, v71
    s_nop 1
    v_mbcnt_lo_u32_b32 v113, s84, 0
    v_mbcnt_hi_u32_b32 v113, s85, v113
    v_add_lshl_u32 v113, v113, s93, 3
    s_bcnt1_i32_b64 s3, s[84:85]
    s_mov_b64 exec, s[84:85]
    ds_write_b64 v113, v[70:71] offset:256
    s_mov_b64 exec, -1
    s_add_u32 s93, s93, s3
    v_cmp_ne_u32 s[84:85], 0, v73
    s_nop 1
    v_mbcnt_lo_u32_b32 v113, s84, 0
    v_mbcnt_hi_u32_b32 v113, s85, v113
    v_add_lshl_u32 v113, v113, s90, 3
    s_bcnt1_i32_b64 s3, s[84:85]
    s_mov_b64 exec, s[84:85]
    ds_write_b64 v113, v[72:73] offset:256
    s_mov_b64 exec, -1
    s_add_u32 s90, s90, s3
    v_cmp_ne_u32 s[84:85], 0, v75
    s_nop 1
    v_mbcnt_lo_u32_b32 v113, s84, 0
    v_mbcnt_hi_u32_b32 v113, s85, v113
    v_add_lshl_u32 v113, v113, s91, 3
    s_bcnt1_i32_b64 s3, s[84:85]
    s_mov_b64 exec, s[84:85]
    ds_write_b64 v113, v[74:75] offset:256
    s_mov_b64 exec, -1
    s_add_u32 s91, s91, s3
    v_cmp_ne_u32 s[84:85], 0, v77
    s_nop 1
    v_mbcnt_lo_u32_b32 v113, s84, 0
    v_mbcnt_hi_u32_b32 v113, s85, v113
    v_add_lshl_u32 v113, v113, s92, 3
    s_bcnt1_i32_b64 s3, s[84:85]
    s_mov_b64 exec, s[84:85]
    ds_write_b64 v113, v[76:77] offset:256
    s_mov_b64 exec, -1
    s_add_u32 s92, s92, s3
    v_cmp_ne_u32 s[84:85], 0, v79
    s_nop 1
    v_mbcnt_lo_u32_b32 v113, s84, 0
    v_mbcnt_hi_u32_b32 v113, s85, v113
    v_add_lshl_u32 v113, v113, s93, 3
    s_bcnt1_i32_b64 s3, s[84:85]
    s_mov_b64 exec, s[84:85]
    ds_write_b64 v113, v[78:79] offset:256
    s_mov_b64 exec, -1
    s_add_u32 s93, s93, s3
    v_cmp_ne_u32 s[84:85], 0, v81
    s_nop 1
    v_mbcnt_lo_u32_b32 v113, s84, 0
    v_mbcnt_hi_u32_b32 v113, s85, v113
    v_add_lshl_u32 v113, v113, s90, 3
    s_bcnt1_i32_b64 s3, s[84:85]
    s_mov_b64 exec, s[84:85]
    ds_write_b64 v113, v[80:81] offset:256
    s_mov_b64 exec, -1
    s_add_u32 s90, s90, s3
    v_cmp_ne_u32 s[84:85], 0, v83
    s_nop 1
    v_mbcnt_lo_u32_b32 v113, s84, 0
    v_mbcnt_hi_u32_b32 v113, s85, v113
    v_add_lshl_u32 v113, v113, s91, 3
    s_bcnt1_i32_b64 s3, s[84:85]
    s_mov_b64 exec, s[84:85]
    ds_write_b64 v113, v[82:83] offset:256
    s_mov_b64 exec, -1
    s_add_u32 s91, s91, s3
    v_cmp_ne_u32 s[84:85], 0, v85
    s_nop 1
    v_mbcnt_lo_u32_b32 v113, s84, 0
    v_mbcnt_hi_u32_b32 v113, s85, v113
    v_add_lshl_u32 v113, v113, s92, 3
    s_bcnt1_i32_b64 s3, s[84:85]
    s_mov_b64 exec, s[84:85]
    ds_write_b64 v113, v[84:85] offset:256
    s_mov_b64 exec, -1
    s_add_u32 s92, s92, s3
    v_cmp_ne_u32 s[84:85], 0, v87
    s_nop 1
    v_mbcnt_lo_u32_b32 v113, s84, 0
    v_mbcnt_hi_u32_b32 v113, s85, v113
    v_add_lshl_u32 v113, v113, s93, 3
    s_bcnt1_i32_b64 s3, s[84:85]
    s_mov_b64 exec, s[84:85]
    ds_write_b64 v113, v[86:87] offset:256
    s_mov_b64 exec, -1
    s_add_u32 s93, s93, s3
    v_cmp_ne_u32 s[84:85], 0, v89
    s_nop 1
    v_mbcnt_lo_u32_b32 v113, s84, 0
    v_mbcnt_hi_u32_b32 v113, s85, v113
    v_add_lshl_u32 v113, v113, s90, 3
    s_bcnt1_i32_b64 s3, s[84:85]
    s_mov_b64 exec, s[84:85]
    ds_write_b64 v113, v[88:89] offset:256
    s_mov_b64 exec, -1
    s_add_u32 s90, s90, s3
    v_cmp_ne_u32 s[84:85], 0, v91
    s_nop 1
    v_mbcnt_lo_u32_b32 v113, s84, 0
    v_mbcnt_hi_u32_b32 v113, s85, v113
    v_add_lshl_u32 v113, v113, s91, 3
    s_bcnt1_i32_b64 s3, s[84:85]
    s_mov_b64 exec, s[84:85]
    ds_write_b64 v113, v[90:91] offset:256
    s_mov_b64 exec, -1
    s_add_u32 s91, s91, s3
    v_cmp_ne_u32 s[84:85], 0, v93
    s_nop 1
    v_mbcnt_lo_u32_b32 v113, s84, 0
    v_mbcnt_hi_u32_b32 v113, s85, v113
    v_add_lshl_u32 v113, v113, s92, 3
    s_bcnt1_i32_b64 s3, s[84:85]
    s_mov_b64 exec, s[84:85]
    ds_write_b64 v113, v[92:93] offset:256
    s_mov_b64 exec, -1
    s_add_u32 s92, s92, s3
    v_cmp_ne_u32 s[84:85], 0, v95
    s_nop 1
    v_mbcnt_lo_u32_b32 v113, s84, 0
    v_mbcnt_hi_u32_b32 v113, s85, v113
    v_add_lshl_u32 v113, v113, s93, 3
    s_bcnt1_i32_b64 s3, s[84:85]
    s_mov_b64 exec, s[84:85]
    ds_write_b64 v113, v[94:95] offset:256
    s_mov_b64 exec, -1
    s_add_u32 s93, s93, s3
    v_mov_b32 v114, s95
    s_waitcnt vmcnt(0) lgkmcnt(0)
    ds_write_b32 v216, v114 offset:0
    v_readfirstlane_b32 s3, v215
    s_nop 0
    s_and_b32 s3, s3, 0xffff
    s_cmp_lg_u32 s3, 0
    s_nop 0
    s_cbranch_scc1 L_b_end
    s_lshl_b32 s3, s37, 11
    s_add_u32 s3, s3, 0x400000
    v_lshlrev_b32 v113, 8, v1
    v_add_u32 v113, s3, v113
    v_mov_b32 v114, 0
    s_mov_b64 exec, 0xff
    global_atomic_swap v100, v113, v114, s[22:23] sc0
    s_waitcnt vmcnt(0)
    v_mov_b32 v114, 0x10000
    s_mov_b64 exec, 1
    global_atomic_add v214, v114, s[20:21]
    s_mov_b64 exec, -1
L_b_end:
    s_waitcnt lgkmcnt(0)
    s_endpgm
L_code_end:
.section .rodata,"a"
.p2align 6
.amdhsa_kernel standalone__paged_block_table_kv_radixattention__decode_kernel
  .amdhsa_next_free_vgpr 220
  .amdhsa_next_free_sgpr 102
  .amdhsa_accum_offset 220
  .amdhsa_group_segment_fixed_size 0
  .amdhsa_kernarg_size 64
  .amdhsa_user_sgpr_count 2
  .amdhsa_user_sgpr_kernarg_segment_ptr 1
  .amdhsa_system_sgpr_workgroup_id_x 1
.end_amdhsa_kernel
```
